```python
import torch

def _softmax(x, axis=-1):
    return torch.softmax(x, dim=axis)

def _gelu(x):
    return torch.nn.functional.gelu(x, approximate='tanh')

def _silu(x):
    return torch.nn.functional.silu(x)

def _sigmoid(x):
    return torch.sigmoid(x)

def _layernorm(x, axis=-1, eps=1e-05):
    m = x.mean(dim=axis, keepdim=True)
    v = x.var(dim=axis, keepdim=True, unbiased=False)
    return (x - m) / torch.sqrt(v + eps)

def _scatter_add(tgt, idx, src, axis=0):
    return tgt.clone().index_add_(axis, idx, src)

def _segment_sum(src, seg, n):
    out = torch.zeros((n,) + src.shape[1:], dtype=src.dtype)
    return out.index_add_(0, seg, src)

def _pad(x, pw):
    flat = tuple((v for pair in reversed(pw) for v in pair))
    return torch.nn.functional.pad(x, flat)
kernel_name = 'adaLN_cond__sliding_local_dilated__dense_activation_relu__prompt'

def setup_inputs():

    _w = lambda a: (lambda t: t.to(torch.bfloat16) if t.is_floating_point() else t)(torch.as_tensor(a))

    def _A_setup():
        B, S, D = (1, 2048, 512)
        return {'x': _w((lambda *s: torch.randn(*s, dtype=torch.bfloat16) * 0.05)(B, S, D)), 'wqkv': _w((lambda *s: torch.randn(*s, dtype=torch.bfloat16) * 0.05)(D, 3 * D)), 'wo': _w((lambda *s: torch.randn(*s, dtype=torch.bfloat16) * 0.05)(D, D))}
    _A_in = _A_setup()

    def _B_setup():
        B, S, D, Dff = (1, 2048, 512, 1376)
        return {'x': _w((lambda *s: torch.randn(*s, dtype=torch.bfloat16) * 0.05)(B, S, D)), 'w1': _w((lambda *s: torch.randn(*s, dtype=torch.bfloat16) * 0.05)(D, Dff)), 'w2': _w((lambda *s: torch.randn(*s, dtype=torch.bfloat16) * 0.05)(Dff, D))}
    _B_in = _B_setup()
    return {'A_x': _A_in['x'], 'A_wqkv': _A_in['wqkv'], 'A_wo': _A_in['wo'], 'B_x': _B_in['x'], 'B_w1': _B_in['w1'], 'B_w2': _B_in['w2'], 'c': _w((lambda *s: torch.randn(*s, dtype=torch.bfloat16) * 0.1)(1, 512) * 8.0), 'w_mod': _w((lambda *s: torch.randn(*s, dtype=torch.bfloat16) * 0.1)(512, 6 * 512) * 512 ** (-0.5) * 8.0)}

def reference(A_x, A_wqkv, A_wo, B_x, B_w1, B_w2, c, w_mod):

    def _A_ref(x, wqkv, wo):
        B, S, D = x.shape
        H = 32
        Dh = D // H
        W, dil = (8, 2)
        qkv = (lambda x, *d: x.permute(*d))((x @ wqkv).reshape(B, S, 3, H, Dh), 2, 0, 3, 1, 4)
        q, k, v = (qkv[0], qkv[1], qkv[2])
        scale = Dh ** (-0.5)
        pos = torch.arange(S)
        off = torch.arange(W) * dil
        idx = pos[:, None] - off[None, :]
        mask = idx >= 0
        idx_c = torch.where(mask, idx, 0).reshape(-1)
        kg = k[:, :, idx_c, :].reshape(B, H, S, W, Dh)
        vg = v[:, :, idx_c, :].reshape(B, H, S, W, Dh)
        logits = torch.einsum('bhsd,bhswd->bhsw', q, kg) * scale
        logits = torch.where(mask[None, None, :, :], logits, -1000000000.0)
        attn = _softmax(logits, axis=-1)
        o = torch.einsum('bhsw,bhswd->bhsd', attn, vg)
        return (lambda x, *d: x.permute(*d))(o, 0, 2, 1, 3).reshape(B, S, D) @ wo

    def _B_ref(x, w1, w2):
        h = torch.einsum('bsd,df->bsf', x, w1)
        zero = torch.zeros_like(h)
        h = torch.maximum(h, zero)
        return torch.einsum('bsf,fd->bsd', h, w2)
    x = A_x
    mod = (_silu(c) @ w_mod).reshape(c.shape[0], 6, 1, -1)
    sa, ca, ga, sb, cb, gb = (mod[:, 0].clone(), mod[:, 1].clone(), mod[:, 2].clone(), mod[:, 3].clone(), mod[:, 4].clone(), mod[:, 5].clone())
    h = _layernorm(x, axis=-1) * (1 + ca) + sa
    x = x + ga * _A_ref(h, A_wqkv, A_wo)
    h = _layernorm(x, axis=-1) * (1 + cb) + sb
    x = x + gb * _B_ref(h, B_w1, B_w2)
    return x
```

```asm
; @launch grid=(256,1,1) block=(256,1,1) lds=163840
.amdgcn_target "amdgcn-amd-amdhsa--gfx950"
.text
.globl adaLN_cond__sliding_local_dilated__dense_activation_relu__prompt_kernel
.p2align 12
.type adaLN_cond__sliding_local_dilated__dense_activation_relu__prompt_kernel,@function
adaLN_cond__sliding_local_dilated__dense_activation_relu__prompt_kernel:
    s_load_dwordx2 s[24:25], s[0:1], 56
    s_load_dwordx2 s[36:37], s[0:1], 48
    s_load_dwordx2 s[4:5], s[0:1], 0
    s_load_dwordx2 s[8:9], s[0:1], 8
    s_load_dwordx2 s[32:33], s[0:1], 80
    s_load_dwordx2 s[12:13], s[0:1], 16
    s_load_dwordx2 s[16:17], s[0:1], 32
    s_load_dwordx2 s[20:21], s[0:1], 40
    s_load_dwordx2 s[28:29], s[0:1], 64
    s_cmp_ge_u32 s2, 256
    s_cbranch_scc1 L_END
    v_lshrrev_b32 v1, 6, v0
    v_and_b32 v241, 63, v0
    s_getpc_b64 s[68:69]
    s_nop 0
L_PC:
    v_readfirstlane_b32 s60, v1
    s_mov_b32 s70, L_END-L_PC
    s_mov_b32 s71, 0x00020000
    v_lshlrev_b32 v247, 7, v241
    s_lshr_b32 s66, s2, 3
    s_lshl2_add_u32 s3, s66, s60
    s_mul_i32 s64, s3, 384
    s_mov_b64 exec, 7
    buffer_load_dword v227, v247, s[68:71], s64 offen
    s_mov_b64 exec, -1
    s_mov_b32 s26, 3145728
    s_mov_b32 s27, 0x00020000
    s_mov_b32 s6, 2097152
    s_mov_b32 s7, 0x00020000
    s_mov_b32 s38, 1024
    s_mov_b32 s39, 0x00020000
    s_mov_b32 s10, 1572864
    s_mov_b32 s11, 0x00020000
    v_lshlrev_b32 v255, 4, v241
    s_and_b32 s64, s2, 7
    s_lshl_b32 s67, s64, 2
    s_lshr_b32 s65, s2, 6
    s_add_u32 s61, s67, s65
    s_and_b32 s62, s66, 7
    s_lshl3_add_u32 s77, s61, s60
    s_lshl_b32 s77, s77, 13
    s_lshr_b32 s64, s60, 1
    s_mul_i32 s64, s64, 17408
    s_sub_u32 s76, s77, s64
    s_sub_u32 s76, s76, 15360
    s_cmp_eq_u32 s61, 0
    s_cselect_b32 s76, 1073741824, s76
    s_cmp_ge_u32 s2, 96
    s_cbranch_scc1 L_NP
    s_add_u32 s78, s67, 28
    s_cmp_lt_u32 s2, 32
    s_cselect_b32 s78, 0, s78
    s_add_u32 s78, s78, s67
    s_add_u32 s78, s78, s66
    v_lshrrev_b32 v83, 2, v241
    v_and_b32 v82, 0x30, v255
    v_mul_u32_u24 v83, 49152, v83
    v_add_u32 v83, v83, v82
    v_lshlrev_b32 v81, 2, v241
    v_lshlrev_b32 v223, 10, v241
    s_mul_i32 s56, s60, 786432
    s_lshl_b32 s57, s78, 6
    s_add_u32 s56, s56, s57
    s_lshl_b32 s57, s60, 8
    s_waitcnt lgkmcnt(0)
    buffer_load_dword v64, v81, s[36:39], s57 offen
    buffer_load_dwordx4 v[0:3], v83, s[24:27], s56 offen
    s_add_u32 s56, s56, 6144
    buffer_load_dwordx4 v[8:11], v83, s[24:27], s56 offen
    s_add_u32 s56, s56, 6144
    buffer_load_dwordx4 v[16:19], v83, s[24:27], s56 offen
    s_add_u32 s56, s56, 6144
    buffer_load_dwordx4 v[24:27], v83, s[24:27], s56 offen
    s_add_u32 s56, s56, 6144
    buffer_load_dwordx4 v[32:35], v83, s[24:27], s56 offen
    s_add_u32 s56, s56, 6144
    buffer_load_dwordx4 v[40:43], v83, s[24:27], s56 offen
    s_add_u32 s56, s56, 6144
    buffer_load_dwordx4 v[48:51], v83, s[24:27], s56 offen
    s_add_u32 s56, s56, 6144
    buffer_load_dwordx4 v[56:59], v83, s[24:27], s56 offen
    s_cmp_lt_u32 s2, 32
    s_cbranch_scc1 L_UH
    s_branch L_LP
L_NP:
    v_lshrrev_b32 v98, 3, v241
    v_mul_u32_u24 v98, 5120, v98
    v_add_u32 v98, v98, v247
    s_sub_u32 s78, s3, 48
    s_lshl_b32 s67, s67, 6
    s_mul_i32 s65, s78, 43008
    s_add_u32 s72, s65, s67
    s_add_u32 s57, s72, s67
    v_lshlrev_b32 v223, 10, v241
    v_lshrrev_b32 v136, 3, v241
    v_lshrrev_b32 v137, 1, v136
    v_lshlrev_b32 v137, 5, v137
    v_and_b32 v141, 0x70, v255
    v_xor_b32 v137, v137, v141
    v_and_b32 v138, 4, v136
    v_add_u32 v139, v136, v138
    v_mul_u32_u24 v138, 3072, v139
    v_add_u32 v246, v138, v137
    s_and_b32 s51, s60, 1
    s_lshl_b32 s51, s51, 4
    s_lshr_b32 s52, s60, 1
    s_lshl2_add_u32 s54, s52, s51
    s_mul_i32 s51, s54, 3072
    s_lshl_b32 s52, s62, 7
    s_add_u32 s51, s51, s52
    s_mul_i32 s52, s60, 3072
    s_mov_b32 exec_lo, 0x03030303
    s_mov_b32 exec_hi, 0x00030303
    s_waitcnt lgkmcnt(0)
    buffer_load_dword v227, v98, s[24:27], s72 offen
    s_mov_b64 exec, -1
    s_lshl_b32 s97, s62, 7
    s_add_u32 s96, s77, s97
    s_add_u32 s97, s76, s97
    s_mov_b64 exec, 0xff
    buffer_load_dword v227, v223, s[4:7], s96 offen
    s_mov_b64 exec, 0x55
    buffer_load_dword v227, v223, s[4:7], s97 offen
    s_mov_b64 exec, -1
    s_lshl4_add_u32 s96, s61, s62
    s_lshl2_add_u32 s96, s96, s60
    s_add_u32 s96, s96, 32
    s_lshl_b32 s96, s96, 10
    buffer_load_dwordx4 v[100:103], v255, s[4:7], s96 offen offset:0
    buffer_load_dwordx4 v[4:7], v255, s[4:7], s76 offen offset:0
    s_add_u32 s32, s32, 251658240
    s_addc_u32 s33, s33, 0
    s_load_dword s46, s[32:33], 0
    s_mov_b32 s34, 16777216
    s_bfm_b64 exec, 20, 0
    s_mul_i32 s56, s78, 20480
    buffer_load_dword v227, v223, s[8:11], s56 offen offset:384
    s_mov_b64 exec, -1
    s_mov_b32 s35, 0x00020000
    s_mov_b32 s14, 524288
    s_mov_b32 s15, 0x00020000
    s_mov_b32 s18, 1409024
    s_mov_b32 s19, 0x00020000
    s_mov_b32 s22, 1409024
    s_mov_b32 s23, 0x00020000
    s_mov_b32 s30, 2097152
    s_mov_b32 s31, 0x00020000
    s_mul_i32 s47, s61, 393216
    s_add_u32 s47, s47, 1048576
    s_add_u32 s59, s47, 360448
    s_lshl2_add_u32 s79, s2, s60
    s_and_b32 s64, s3, 7
    s_lshl_b32 s64, s64, 7
    s_bfm_b64 exec, 5, 0
    s_mul_i32 s56, s79, 640
    s_add_u32 s56, s56, 4294721536
    buffer_load_dword v227, v247, s[8:11], s56 offen offset:0
    s_mov_b64 exec, -1
    s_add_u32 s64, s64, s59
    s_load_dword s40, s[32:33], s64
    s_sub_u32 s64, s47, 128
    s_load_dword s40, s[32:33], s64
    s_load_dword s40, s[28:29], 0
    s_load_dword s40, s[12:13], 0
    s_load_dword s40, s[16:17], 0
    s_load_dword s40, s[20:21], 0
    s_and_b32 s64, s3, 31
    s_lshl2_add_u32 s58, s64, s59
    s_mov_b32 s41, 0x3f803f80
    v_lshrrev_b32 v243, 4, v241
    v_and_b32 v242, 15, v241
    s_lshl_b32 s64, s60, 5
    v_xor_b32 v142, s64, v141
    s_lshl_b32 s65, s60, 9
    s_add_u32 s65, s65, 73728
    v_add_u32 v142, s65, v142
    v_mul_u32_u24 v143, 6144, v136
    v_add_u32 v164, v142, v143
    v_xor_b32 v165, 16, v164
    s_lshl_b32 s65, s62, 4
    v_xor_b32 v142, s65, v141
    v_lshl_add_u32 v240, v136, 12, v142
    s_and_b32 s66, s60, 1
    s_lshl_b32 s66, s66, 4
    s_lshr_b32 s65, s60, 1
    s_lshl1_add_u32 s65, s62, s65
    s_add_u32 s66, s66, s65
    s_lshl_b32 s66, s66, 7
    s_add_u32 s82, s47, 327680
    s_add_u32 s82, s82, s66
    s_mov_b32 s50, 32768
    v_lshrrev_b32 v142, 1, v242
    v_xor_b32 v142, v142, v243
    v_lshlrev_b32 v142, 4, v142
    v_lshl_add_u32 v142, v242, 7, v142
    v_add_u32 v235, 73728, v142
    v_xor_b32 v236, 64, v235
    v_bfe_u32 v144, v241, 2, 3
    v_lshrrev_b32 v145, 1, v144
    v_lshlrev_b32 v145, 5, v145
    v_and_b32 v146, 3, v241
    v_lshlrev_b32 v146, 3, v146
    v_lshl_add_u32 v146, v144, 7, v146
    buffer_load_dwordx4 v[12:15], v255, s[4:7], s76 offen offset:2048
    v_lshrrev_b32 v147, 5, v241
    v_mul_u32_u24 v142, 3072, v147
    v_add_u32 v146, v146, v142
    v_xor_b32 v142, s64, v145
    v_add_u32 v248, v146, v142
    v_add_u32 v249, 73728, v248
    v_lshlrev_b32 v148, 2, v243
    v_sub_u32 v148, v148, v242
    v_mov_b32 v149, 0xf149f2ca
    s_cmp_eq_u32 s61, 0
    s_cselect_b32 s66, 100, 9
    s_cselect_b32 s67, 100, 1
    v_and_b32 v150, 2, v243
    v_lshlrev_b32 v150, 6, v150
    v_sub_u32 v150, v148, v150
    v_add_u32 v151, 7, v148
    s_add_u32 s76, s76, 4096
    buffer_load_dwordx4 v[20:23], v255, s[4:7], s76 offen offset:0
    v_add_u32 v152, 0, v148
    v_add_u32 v153, 0, v150
    v_cmp_gt_u32 vcc, 8, v151
    v_cmp_le_i32 s[72:73], 9, v152
    v_cmp_le_i32 s[74:75], s66, v152
    v_cmp_le_i32 s[48:49], s67, v153
    v_cndmask_b32 v166, v149, 0, vcc
    v_cndmask_b32 v156, 0, -1, vcc
    v_cndmask_b32 v170, v149, 0, s[72:73]
    v_cndmask_b32 v174, v149, 0, s[74:75]
    v_cndmask_b32 v178, v149, 0, s[48:49]
    v_add_u32 v151, 8, v148
    v_add_u32 v152, 1, v148
    v_add_u32 v153, 1, v150
    v_cmp_gt_u32 vcc, 8, v151
    buffer_load_dwordx4 v[28:31], v255, s[4:7], s76 offen offset:2048
    v_cmp_le_i32 s[72:73], 9, v152
    v_cmp_le_i32 s[74:75], s66, v152
    v_cmp_le_i32 s[48:49], s67, v153
    v_cndmask_b32 v167, v149, 0, vcc
    v_cndmask_b32 v157, 0, -1, vcc
    v_cndmask_b32 v171, v149, 0, s[72:73]
    v_cndmask_b32 v175, v149, 0, s[74:75]
    v_cndmask_b32 v179, v149, 0, s[48:49]
    v_add_u32 v151, 9, v148
    v_add_u32 v152, 2, v148
    v_add_u32 v153, 2, v150
    v_cmp_gt_u32 vcc, 8, v151
    v_cmp_le_i32 s[72:73], 9, v152
    v_cmp_le_i32 s[74:75], s66, v152
    v_cmp_le_i32 s[48:49], s67, v153
    buffer_load_dwordx4 v[36:39], v255, s[4:7], s77 offen offset:0
    v_cndmask_b32 v168, v149, 0, vcc
    v_cndmask_b32 v158, 0, -1, vcc
    v_cndmask_b32 v172, v149, 0, s[72:73]
    v_cndmask_b32 v176, v149, 0, s[74:75]
    v_cndmask_b32 v180, v149, 0, s[48:49]
    v_add_u32 v151, 10, v148
    v_add_u32 v152, 3, v148
    v_add_u32 v153, 3, v150
    v_cmp_gt_u32 vcc, 8, v151
    v_cmp_le_i32 s[72:73], 9, v152
    v_cmp_le_i32 s[74:75], s66, v152
    v_cmp_le_i32 s[48:49], s67, v153
    v_cndmask_b32 v169, v149, 0, vcc
    v_cndmask_b32 v159, 0, -1, vcc
    v_cndmask_b32 v173, v149, 0, s[72:73]
    buffer_load_dwordx4 v[44:47], v255, s[4:7], s77 offen offset:1024
    v_cndmask_b32 v177, v149, 0, s[74:75]
    v_cndmask_b32 v181, v149, 0, s[48:49]
    v_mov_b32 v151, 0xffff
    v_bfi_b32 v182, v151, v156, v157
    v_bfi_b32 v183, v151, v158, v159
    v_mov_b32 v184, s41
    v_mov_b32 v185, s41
    v_and_b32 v228, 31, v241
    v_lshlrev_b32 v228, 2, v228
    s_and_b32 s64, s60, 1
    s_lshl_b32 s65, s64, 6
    v_lshlrev_b32 v234, 11, v242
    v_lshl_add_u32 v234, v243, 4, v234
    s_lshr_b32 s66, s60, 1
    s_lshl_b32 s67, s61, 6
    buffer_load_dwordx4 v[52:55], v255, s[4:7], s77 offen offset:2048
    s_add_u32 s67, s67, s66
    s_lshl_b32 s67, s67, 10
    s_lshl_b32 s42, s62, 7
    s_add_u32 s42, s42, s65
    s_lshl_b32 s53, s60, 12
    s_lshl_b32 s84, s60, 13
    s_add_u32 s83, s84, s47
    s_add_u32 s101, s83, 327680
    v_lshlrev_b32 v223, 10, v241
    v_lshl_add_u32 v250, v139, 10, v137
    v_add_u32 v251, 15360, v250
    v_add_u32 v252, 2048, v250
    v_add_u32 v253, 17408, v250
    v_and_b32 v140, 0x30, v255
    v_xor_b32 v140, v140, v145
    buffer_load_dwordx4 v[60:63], v255, s[4:7], s77 offen offset:3072
    v_lshl_add_u32 v140, v144, 7, v140
    v_lshl_add_u32 v140, v147, 10, v140
    v_add_u32 v226, s53, v140
    v_xor_b32 v226, s65, v226
    v_xor_b32 v225, 64, v226
    v_lshlrev_b32 v219, 4, v243
    s_add_u32 s65, s42, 155648
    v_add_u32 v219, s65, v219
    s_add_u32 s42, s42, s67
    s_add_u32 s43, s42, 32768
    s_lshl_b32 s99, s60, 10
    s_add_u32 s99, s99, 36864
    s_add_u32 s100, s99, 4096
    v_add_u32 v237, 49152, v235
    v_add_u32 v238, 49152, v236
    s_add_u32 s77, s77, 4096
    buffer_load_dwordx4 v[68:71], v255, s[4:7], s77 offen offset:0
    v_mul_u32_u24 v138, 2752, v139
    v_add_u32 v245, v138, v137
    s_min_u32 s65, s62, 3
    s_mul_i32 s55, s62, 5
    s_add_u32 s55, s55, s65
    s_mul_i32 s54, s54, 2752
    s_lshl_b32 s65, s55, 6
    s_add_u32 s54, s54, s65
    v_add_u32 v138, s55, v139
    v_and_b32 v138, 1, v138
    v_lshl_add_u32 v245, v138, 6, v245
    s_cmp_ge_u32 s62, 3
    s_cselect_b32 s65, 64, 0
    v_or_b32 v140, s65, v137
    v_lshrrev_b32 v140, 6, v140
    v_and_b32 v140, v140, v138
    buffer_load_dwordx4 v[76:79], v255, s[4:7], s77 offen offset:1024
    v_mul_u32_u24 v140, 384, v140
    v_sub_u32 v244, v245, v140
    v_add_u32 v244, 256, v244
    s_mov_b32 s44, 0x3eb8aa3b
    s_mov_b32 s45, 0x3eb8aa3b
    v_lshrrev_b32 v136, 1, v243
    v_lshlrev_b32 v218, 2, v136
    v_lshl_add_u32 v218, v242, 3, v218
    v_lshlrev_b32 v136, 8, v136
    v_lshl_add_u32 v136, v242, 4, v136
    v_and_b32 v137, 1, v243
    v_lshl_add_u32 v233, v137, 14, v136
    v_mul_u32_u24 v137, 45056, v137
    v_add_u32 v232, v137, v136
    s_lshl_b32 s80, s62, 11
    buffer_load_dwordx4 v[84:87], v255, s[4:7], s77 offen offset:2048
    s_add_u32 s80, s80, s47
    s_lshl_b32 s65, s66, 14
    s_add_u32 s81, s80, s65
    s_lshl_b32 s65, s64, 10
    s_add_u32 s81, s81, s65
    s_add_u32 s81, s81, 65536
    s_lshl_b32 s65, s60, 9
    s_add_u32 s80, s80, s65
    s_add_u32 s80, s80, 0
    s_add_u32 s85, s47, 311296
    s_lshl_b32 s65, s66, 11
    s_lshl_b32 s98, s64, 7
    s_add_u32 s98, s98, s65
    s_lshl_b32 s65, s62, 8
    s_add_u32 s98, s98, s65
    buffer_load_dwordx4 v[92:95], v255, s[4:7], s77 offen offset:3072
    s_add_u32 s98, s98, s85
    s_add_u32 s83, s83, 65536
    v_add_u32 v136, s55, v144
    v_and_b32 v136, 1, v136
    v_lshlrev_b32 v136, 1, v136
    s_mul_i32 s64, s60, 3
    v_sub_u32 v136, s64, v136
    v_add_u32 v137, 0, v136
    v_add_u32 v138, 12, v136
    v_min_u32 v137, v137, v138
    v_and_b32 v138, 3, v137
    v_lshlrev_b32 v138, 5, v138
    v_xor_b32 v138, v138, v145
    v_and_b32 v137, 12, v137
    s_bfm_b64 exec, 15, 0
    s_mul_i32 s56, s79, 1920
    s_add_u32 s56, s56, 4294623232
    buffer_load_dword v227, v247, s[8:11], s56 offen offset:0
    s_mov_b64 exec, -1
    v_lshl_add_u32 v137, v137, 8, v146
    v_add_u32 v229, v137, v138
    v_add_u32 v137, 1, v136
    v_add_u32 v138, 13, v136
    v_min_u32 v137, v137, v138
    v_and_b32 v138, 3, v137
    v_lshlrev_b32 v138, 5, v138
    v_xor_b32 v138, v138, v145
    v_and_b32 v137, 12, v137
    v_lshl_add_u32 v137, v137, 8, v146
    v_add_u32 v230, v137, v138
    v_add_u32 v137, 2, v136
    v_add_u32 v138, 14, v136
    v_min_u32 v137, v137, v138
    v_and_b32 v138, 3, v137
    s_bfm_b64 exec, 7, 0
    s_mul_i32 s56, s79, 896
    s_add_u32 s56, s56, 4294623232
    buffer_load_dword v227, v247, s[12:15], s56 offen offset:0
    s_mov_b64 exec, -1
    v_lshlrev_b32 v138, 5, v138
    v_xor_b32 v138, v138, v145
    v_and_b32 v137, 12, v137
    v_lshl_add_u32 v137, v137, 8, v146
    v_add_u32 v231, v137, v138
    s_xor_b32 s65, s60, 3
    s_mul_i32 s65, s65, 6144
    s_add_u32 s65, s65, 90112
    v_add_u32 v214, s65, v255
    s_xor_b32 s65, s60, 2
    s_mul_i32 s65, s65, 6144
    s_add_u32 s65, s65, 90112
    v_add_u32 v215, s65, v255
    s_xor_b32 s65, s60, 1
    s_mul_i32 s65, s65, 6144
    s_bfm_b64 exec, 18, 0
    s_mul_i32 s56, s79, 2304
    s_add_u32 s56, s56, 4294082560
    buffer_load_dword v227, v247, s[16:19], s56 offen offset:0
    s_mov_b64 exec, -1
    s_add_u32 s65, s65, 90112
    v_add_u32 v216, s65, v255
    s_xor_b32 s65, s60, 0
    s_mul_i32 s65, s65, 6144
    s_add_u32 s65, s65, 90112
    v_add_u32 v217, s65, v255
    s_cmp_eq_u32 s60, 0
    s_cbranch_scc1 L_HN00
    s_cmp_eq_u32 s60, 1
    s_cbranch_scc1 L_HN01
    s_cmp_eq_u32 s60, 2
    s_cbranch_scc1 L_HN02
    s_branch L_HN03
L_BN0:
    s_cmp_eq_u32 s60, 0
    s_cbranch_scc1 L_HN10
    s_cmp_eq_u32 s60, 1
    s_cbranch_scc1 L_HN11
    s_cmp_eq_u32 s60, 2
    s_cbranch_scc1 L_HN12
    s_branch L_HN13
L_BN1:
    s_waitcnt vmcnt(16)
    v_dot2_f32_bf16 v104, s41, v4, 0
    v_dot2_f32_bf16 v120, v4, v4, 0
    s_waitcnt vmcnt(13)
    v_dot2_f32_bf16 v105, s41, v12, 0
    v_dot2_f32_bf16 v121, v12, v12, 0
    v_dot2c_f32_bf16 v104, s41, v5
    v_dot2c_f32_bf16 v120, v5, v5
    v_dot2c_f32_bf16 v105, s41, v13
    s_add_u32 m0, s52, 73728
    s_nop 0
    buffer_load_dwordx4 v246, s[8:11], s51 offen offset:0 lds
    v_dot2c_f32_bf16 v121, v13, v13
    v_dot2c_f32_bf16 v104, s41, v6
    v_dot2c_f32_bf16 v120, v6, v6
    v_dot2c_f32_bf16 v105, s41, v14
    v_dot2c_f32_bf16 v121, v14, v14
    v_dot2c_f32_bf16 v104, s41, v7
    v_dot2c_f32_bf16 v120, v7, v7
    v_dot2c_f32_bf16 v105, s41, v15
    v_dot2c_f32_bf16 v121, v15, v15
    s_waitcnt vmcnt(13)
    v_dot2_f32_bf16 v106, s41, v20, 0
    v_dot2_f32_bf16 v122, v20, v20, 0
    s_waitcnt vmcnt(12)
    v_dot2_f32_bf16 v107, s41, v28, 0
    v_dot2_f32_bf16 v123, v28, v28, 0
    v_dot2c_f32_bf16 v106, s41, v21
    v_dot2c_f32_bf16 v122, v21, v21
    buffer_load_dwordx4 v246, s[8:11], s51 offen offset:1024 lds
    v_dot2c_f32_bf16 v107, s41, v29
    v_dot2c_f32_bf16 v123, v29, v29
    v_dot2c_f32_bf16 v106, s41, v22
    v_dot2c_f32_bf16 v122, v22, v22
    v_dot2c_f32_bf16 v107, s41, v30
    v_dot2c_f32_bf16 v123, v30, v30
    v_dot2c_f32_bf16 v106, s41, v23
    v_dot2c_f32_bf16 v122, v23, v23
    v_dot2c_f32_bf16 v107, s41, v31
    v_dot2c_f32_bf16 v123, v31, v31
    v_lshlrev_b32 v0, 16, v4
    v_and_b32 v1, 0xffff0000, v4
    v_lshlrev_b32 v2, 16, v5
    v_and_b32 v3, 0xffff0000, v5
    v_lshlrev_b32 v4, 16, v6
    buffer_load_dwordx4 v246, s[8:11], s51 offen offset:2048 lds
    s_add_u32 s51, s51, 98304
    v_and_b32 v5, 0xffff0000, v6
    v_lshlrev_b32 v6, 16, v7
    v_and_b32 v7, 0xffff0000, v7
    v_lshlrev_b32 v8, 16, v12
    v_and_b32 v9, 0xffff0000, v12
    v_lshlrev_b32 v10, 16, v13
    v_and_b32 v11, 0xffff0000, v13
    v_lshlrev_b32 v12, 16, v14
    v_and_b32 v13, 0xffff0000, v14
    v_lshlrev_b32 v14, 16, v15
    v_and_b32 v15, 0xffff0000, v15
    s_waitcnt vmcnt(13)
    v_dot2_f32_bf16 v108, s41, v36, 0
    v_dot2_f32_bf16 v124, v36, v36, 0
    s_waitcnt vmcnt(12)
    v_dot2_f32_bf16 v109, s41, v44, 0
    v_dot2_f32_bf16 v125, v44, v44, 0
    s_add_u32 m0, s52, 86016
    s_nop 0
    buffer_load_dwordx4 v246, s[8:11], s51 offen offset:0 lds
    v_dot2c_f32_bf16 v108, s41, v37
    v_dot2c_f32_bf16 v124, v37, v37
    v_dot2c_f32_bf16 v109, s41, v45
    v_dot2c_f32_bf16 v125, v45, v45
    v_dot2c_f32_bf16 v108, s41, v38
    v_dot2c_f32_bf16 v124, v38, v38
    v_dot2c_f32_bf16 v109, s41, v46
    v_dot2c_f32_bf16 v125, v46, v46
    v_dot2c_f32_bf16 v108, s41, v39
    v_dot2c_f32_bf16 v124, v39, v39
    v_dot2c_f32_bf16 v109, s41, v47
    v_dot2c_f32_bf16 v125, v47, v47
    v_lshlrev_b32 v16, 16, v20
    v_and_b32 v17, 0xffff0000, v20
    v_lshlrev_b32 v18, 16, v21
    buffer_load_dwordx4 v246, s[8:11], s51 offen offset:1024 lds
    v_and_b32 v19, 0xffff0000, v21
    v_lshlrev_b32 v20, 16, v22
    v_and_b32 v21, 0xffff0000, v22
    v_lshlrev_b32 v22, 16, v23
    v_and_b32 v23, 0xffff0000, v23
    v_lshlrev_b32 v24, 16, v28
    v_and_b32 v25, 0xffff0000, v28
    v_lshlrev_b32 v26, 16, v29
    v_and_b32 v27, 0xffff0000, v29
    v_lshlrev_b32 v28, 16, v30
    v_and_b32 v29, 0xffff0000, v30
    v_lshlrev_b32 v30, 16, v31
    v_and_b32 v31, 0xffff0000, v31
    s_waitcnt vmcnt(13)
    v_dot2_f32_bf16 v110, s41, v52, 0
    v_dot2_f32_bf16 v126, v52, v52, 0
    buffer_load_dwordx4 v246, s[8:11], s51 offen offset:2048 lds
    s_add_u32 s51, s51, 98304
    s_waitcnt vmcnt(13)
    v_dot2_f32_bf16 v111, s41, v60, 0
    v_dot2_f32_bf16 v127, v60, v60, 0
    v_dot2c_f32_bf16 v110, s41, v53
    v_dot2c_f32_bf16 v126, v53, v53
    v_dot2c_f32_bf16 v111, s41, v61
    v_dot2c_f32_bf16 v127, v61, v61
    v_dot2c_f32_bf16 v110, s41, v54
    v_dot2c_f32_bf16 v126, v54, v54
    v_dot2c_f32_bf16 v111, s41, v62
    v_dot2c_f32_bf16 v127, v62, v62
    v_dot2c_f32_bf16 v110, s41, v55
    v_dot2c_f32_bf16 v126, v55, v55
    v_dot2c_f32_bf16 v111, s41, v63
    v_dot2c_f32_bf16 v127, v63, v63
    s_waitcnt lgkmcnt(0)
    s_mul_i32 s63, s46, 1664525
    s_add_u32 s63, s63, 1013904223
    v_mov_b32 v254, s63
    s_getreg_b32 s97, hwreg(HW_REG_XCC_ID, 0, 4)
    s_lshl4_add_u32 s96, s63, s97
    v_writelane_b32 v254, s96, 1
    s_mov_b32 s97, 0
    s_nop 0
    s_branch L_O0
.p2alignl 12, 0xbf810000
L_HN00:
    s_branch L_BN0
L_HU00:
    s_branch L_BU0
L_HL00:
    s_branch L_BL0
L_O0:
L_J:
    v_lshlrev_b32 v32, 16, v36
    s_add_u32 m0, s52, 98304
    s_nop 0
    buffer_load_dwordx4 v246, s[8:11], s51 offen offset:0 lds
    v_and_b32 v33, 0xffff0000, v36
    v_lshlrev_b32 v34, 16, v37
    v_and_b32 v35, 0xffff0000, v37
    v_lshlrev_b32 v36, 16, v38
    v_and_b32 v37, 0xffff0000, v38
    v_lshlrev_b32 v38, 16, v39
    v_and_b32 v39, 0xffff0000, v39
    v_lshlrev_b32 v40, 16, v44
    v_and_b32 v41, 0xffff0000, v44
    v_lshlrev_b32 v42, 16, v45
    v_and_b32 v43, 0xffff0000, v45
    v_lshlrev_b32 v44, 16, v46
    buffer_load_dwordx4 v246, s[8:11], s51 offen offset:1024 lds
    v_and_b32 v45, 0xffff0000, v46
    v_lshlrev_b32 v46, 16, v47
    v_and_b32 v47, 0xffff0000, v47
    s_waitcnt vmcnt(14)
    v_dot2_f32_bf16 v112, s41, v68, 0
    v_dot2_f32_bf16 v128, v68, v68, 0
    s_waitcnt vmcnt(13)
    v_dot2_f32_bf16 v113, s41, v76, 0
    v_dot2_f32_bf16 v129, v76, v76, 0
    v_dot2c_f32_bf16 v112, s41, v69
    v_dot2c_f32_bf16 v128, v69, v69
    v_dot2c_f32_bf16 v113, s41, v77
    v_dot2c_f32_bf16 v129, v77, v77
    v_dot2c_f32_bf16 v112, s41, v70
    buffer_load_dwordx4 v246, s[8:11], s51 offen offset:2048 lds
    s_add_u32 s51, s51, 98304
    v_dot2c_f32_bf16 v128, v70, v70
    v_dot2c_f32_bf16 v113, s41, v78
    v_dot2c_f32_bf16 v129, v78, v78
    v_dot2c_f32_bf16 v112, s41, v71
    v_dot2c_f32_bf16 v128, v71, v71
    v_dot2c_f32_bf16 v113, s41, v79
    v_dot2c_f32_bf16 v129, v79, v79
    v_lshlrev_b32 v48, 16, v52
    v_and_b32 v49, 0xffff0000, v52
    v_lshlrev_b32 v50, 16, v53
    v_and_b32 v51, 0xffff0000, v53
    v_lshlrev_b32 v52, 16, v54
    s_add_u32 m0, s52, 110592
    s_nop 0
    buffer_load_dwordx4 v246, s[8:11], s51 offen offset:0 lds
    v_and_b32 v53, 0xffff0000, v54
    v_lshlrev_b32 v54, 16, v55
    v_and_b32 v55, 0xffff0000, v55
    v_lshlrev_b32 v56, 16, v60
    v_and_b32 v57, 0xffff0000, v60
    v_lshlrev_b32 v58, 16, v61
    v_and_b32 v59, 0xffff0000, v61
    v_lshlrev_b32 v60, 16, v62
    v_and_b32 v61, 0xffff0000, v62
    v_lshlrev_b32 v62, 16, v63
    v_and_b32 v63, 0xffff0000, v63
    s_waitcnt vmcnt(14)
    v_dot2_f32_bf16 v114, s41, v84, 0
    buffer_load_dwordx4 v246, s[8:11], s51 offen offset:1024 lds
    v_dot2_f32_bf16 v130, v84, v84, 0
    s_waitcnt vmcnt(14)
    v_dot2_f32_bf16 v115, s41, v92, 0
    v_dot2_f32_bf16 v131, v92, v92, 0
    v_dot2_f32_bf16 v116, s41, v100, 0
    v_dot2_f32_bf16 v132, v100, v100, 0
    v_dot2c_f32_bf16 v114, s41, v85
    v_dot2c_f32_bf16 v130, v85, v85
    v_dot2c_f32_bf16 v115, s41, v93
    v_dot2c_f32_bf16 v131, v93, v93
    v_dot2c_f32_bf16 v116, s41, v101
    v_dot2c_f32_bf16 v132, v101, v101
    v_dot2c_f32_bf16 v114, s41, v86
    v_dot2c_f32_bf16 v130, v86, v86
    buffer_load_dwordx4 v246, s[8:11], s51 offen offset:2048 lds
    s_add_u32 s51, s51, 98304
    v_dot2c_f32_bf16 v115, s41, v94
    v_dot2c_f32_bf16 v131, v94, v94
    v_dot2c_f32_bf16 v116, s41, v102
    v_dot2c_f32_bf16 v132, v102, v102
    v_dot2c_f32_bf16 v114, s41, v87
    v_dot2c_f32_bf16 v130, v87, v87
    v_dot2c_f32_bf16 v115, s41, v95
    v_dot2c_f32_bf16 v131, v95, v95
    v_dot2c_f32_bf16 v116, s41, v103
    v_dot2c_f32_bf16 v132, v103, v103
    v_lshlrev_b32 v64, 16, v68
    v_and_b32 v65, 0xffff0000, v68
    s_add_u32 m0, s52, 122880
    s_nop 0
    buffer_load_dwordx4 v246, s[8:11], s51 offen offset:0 lds
    v_lshlrev_b32 v66, 16, v69
    v_and_b32 v67, 0xffff0000, v69
    v_lshlrev_b32 v68, 16, v70
    v_and_b32 v69, 0xffff0000, v70
    v_lshlrev_b32 v70, 16, v71
    v_and_b32 v71, 0xffff0000, v71
    v_lshlrev_b32 v72, 16, v76
    v_and_b32 v73, 0xffff0000, v76
    v_lshlrev_b32 v74, 16, v77
    v_and_b32 v75, 0xffff0000, v77
    v_lshlrev_b32 v76, 16, v78
    v_and_b32 v77, 0xffff0000, v78
    buffer_load_dwordx4 v246, s[8:11], s51 offen offset:1024 lds
    v_lshlrev_b32 v78, 16, v79
    v_and_b32 v79, 0xffff0000, v79
    v_lshlrev_b32 v80, 16, v84
    v_and_b32 v81, 0xffff0000, v84
    v_lshlrev_b32 v82, 16, v85
    v_and_b32 v83, 0xffff0000, v85
    v_lshlrev_b32 v84, 16, v86
    v_and_b32 v85, 0xffff0000, v86
    v_lshlrev_b32 v86, 16, v87
    v_permlane32_swap_b32 v104, v105
    v_permlane32_swap_b32 v106, v107
    v_permlane32_swap_b32 v108, v109
    buffer_load_dwordx4 v246, s[8:11], s51 offen offset:2048 lds
    s_add_u32 s51, s51, 98304
    v_permlane32_swap_b32 v110, v111
    v_permlane32_swap_b32 v112, v113
    v_permlane32_swap_b32 v114, v115
    v_permlane32_swap_b32 v116, v117
    v_permlane32_swap_b32 v120, v121
    v_permlane32_swap_b32 v122, v123
    v_permlane32_swap_b32 v124, v125
    v_permlane32_swap_b32 v126, v127
    v_permlane32_swap_b32 v128, v129
    v_permlane32_swap_b32 v130, v131
    v_permlane32_swap_b32 v132, v133
    v_add_f32 v104, v104, v105
    v_add_f32 v106, v106, v107
    s_add_u32 m0, s52, 135168
    s_nop 0
    buffer_load_dwordx4 v246, s[8:11], s51 offen offset:0 lds
    v_add_f32 v108, v108, v109
    v_add_f32 v110, v110, v111
    v_add_f32 v112, v112, v113
    v_add_f32 v114, v114, v115
    v_add_f32 v116, v116, v117
    v_add_f32 v120, v120, v121
    v_add_f32 v122, v122, v123
    v_add_f32 v124, v124, v125
    v_add_f32 v126, v126, v127
    v_add_f32 v128, v128, v129
    v_add_f32 v130, v130, v131
    v_add_f32 v132, v132, v133
    buffer_load_dwordx4 v246, s[8:11], s51 offen offset:1024 lds
    v_permlane16_swap_b32 v104, v106
    v_permlane16_swap_b32 v108, v110
    v_permlane16_swap_b32 v112, v114
    v_permlane16_swap_b32 v116, v118
    v_permlane16_swap_b32 v120, v122
    v_permlane16_swap_b32 v124, v126
    v_permlane16_swap_b32 v128, v130
    v_permlane16_swap_b32 v132, v134
    v_add_f32 v104, v104, v106
    v_add_f32 v108, v108, v110
    v_add_f32 v112, v112, v114
    v_add_f32 v116, v116, v118
    buffer_load_dwordx4 v246, s[8:11], s51 offen offset:2048 lds
    s_add_u32 s51, s51, 98304
    v_add_f32 v120, v120, v122
    v_add_f32 v124, v124, v126
    v_add_f32 v128, v128, v130
    v_add_f32 v132, v132, v134
    v_add_f32_dpp v104, v104, v104 row_ror:8 row_mask:0xf bank_mask:0x3
    v_add_f32_dpp v120, v120, v120 row_ror:8 row_mask:0xf bank_mask:0x3
    v_add_f32_dpp v112, v112, v112 row_ror:8 row_mask:0xf bank_mask:0x3
    v_add_f32_dpp v128, v128, v128 row_ror:8 row_mask:0xf bank_mask:0x3
    v_add_f32_dpp v104, v108, v108 row_ror:8 row_mask:0xf bank_mask:0xc
    v_add_f32_dpp v120, v124, v124 row_ror:8 row_mask:0xf bank_mask:0xc
    v_add_f32_dpp v112, v116, v116 row_ror:8 row_mask:0xf bank_mask:0xc
    v_add_f32_dpp v128, v132, v132 row_ror:8 row_mask:0xf bank_mask:0xc
    buffer_load_dwordx4 v[186:189], v255, s[32:35], s50 offen offset:0 sc1
    v_add_f32_dpp v104, v104, v104 row_shl:4 row_mask:0xf bank_mask:0x5
    v_and_b32 v87, 0xffff0000, v87
    v_add_f32_dpp v120, v120, v120 row_shl:4 row_mask:0xf bank_mask:0x5
    v_lshlrev_b32 v88, 16, v92
    v_add_f32_dpp v104, v112, v112 row_shr:4 row_mask:0xf bank_mask:0xa
    v_and_b32 v89, 0xffff0000, v92
    v_add_f32_dpp v120, v128, v128 row_shr:4 row_mask:0xf bank_mask:0xa
    v_lshlrev_b32 v90, 16, v93
    v_add_f32_dpp v104, v104, v104 quad_perm:[1,0,3,2] row_mask:0xf bank_mask:0xf
    v_and_b32 v91, 0xffff0000, v93
    v_add_f32_dpp v120, v120, v120 quad_perm:[1,0,3,2] row_mask:0xf bank_mask:0xf
    v_lshlrev_b32 v92, 16, v94
    v_add_f32_dpp v104, v104, v104 quad_perm:[2,3,0,1] row_mask:0xf bank_mask:0xf
    buffer_load_dwordx4 v[190:193], v255, s[32:35], s50 offen offset:1024 sc1
    v_and_b32 v93, 0xffff0000, v94
    v_add_f32_dpp v120, v120, v120 quad_perm:[2,3,0,1] row_mask:0xf bank_mask:0xf
    v_lshlrev_b32 v94, 16, v95
    v_mul_f32 v104, 0x3b000000, v104
    v_and_b32 v95, 0xffff0000, v95
    v_mul_f32 v120, 0x3b000000, v120
    v_lshlrev_b32 v96, 16, v100
    v_fma_f32 v120, -v104, v104, v120
    v_and_b32 v97, 0xffff0000, v100
    v_max_f32 v120, 0, v120
    v_lshlrev_b32 v98, 16, v101
    v_add_f32 v120, 0x3727c5ac, v120
    buffer_load_dwordx4 v[194:197], v255, s[32:35], s50 offen offset:2048 sc1
    v_and_b32 v99, 0xffff0000, v101
    v_rsq_f32 v120, v120
    v_lshlrev_b32 v100, 16, v102
    v_mul_f32_e64 v104, -v104, v120
    v_and_b32 v101, 0xffff0000, v102
    v_lshlrev_b32 v102, 16, v103
    v_and_b32 v103, 0xffff0000, v103
    v_readlane_b32 s72, v104, 0
    v_readlane_b32 s73, v120, 0
    v_readlane_b32 s74, v104, 32
    v_readlane_b32 s75, v120, 32
    v_pk_fma_f32 v[0:1], v[0:1], s[72:73], s[72:73] op_sel:[0,1,0] op_sel_hi:[1,1,0]
    buffer_load_dwordx4 v[198:201], v255, s[32:35], s50 offen offset:3072 sc1
    v_pk_fma_f32 v[2:3], v[2:3], s[72:73], s[72:73] op_sel:[0,1,0] op_sel_hi:[1,1,0]
    v_pk_fma_f32 v[4:5], v[4:5], s[72:73], s[72:73] op_sel:[0,1,0] op_sel_hi:[1,1,0]
    v_pk_fma_f32 v[6:7], v[6:7], s[72:73], s[72:73] op_sel:[0,1,0] op_sel_hi:[1,1,0]
    v_readlane_b32 s48, v104, 16
    v_readlane_b32 s49, v120, 16
    v_pk_fma_f32 v[8:9], v[8:9], s[74:75], s[74:75] op_sel:[0,1,0] op_sel_hi:[1,1,0]
    v_pk_fma_f32 v[10:11], v[10:11], s[74:75], s[74:75] op_sel:[0,1,0] op_sel_hi:[1,1,0]
    v_pk_fma_f32 v[12:13], v[12:13], s[74:75], s[74:75] op_sel:[0,1,0] op_sel_hi:[1,1,0]
    v_pk_fma_f32 v[14:15], v[14:15], s[74:75], s[74:75] op_sel:[0,1,0] op_sel_hi:[1,1,0]
    v_readlane_b32 s72, v104, 48
    v_readlane_b32 s73, v120, 48
    v_pk_fma_f32 v[16:17], v[16:17], s[48:49], s[48:49] op_sel:[0,1,0] op_sel_hi:[1,1,0]
    s_add_u32 m0, s52, 0
    s_nop 0
    buffer_load_dwordx4 v246, s[8:11], s51 offen offset:0 lds
    v_pk_fma_f32 v[18:19], v[18:19], s[48:49], s[48:49] op_sel:[0,1,0] op_sel_hi:[1,1,0]
    v_pk_fma_f32 v[20:21], v[20:21], s[48:49], s[48:49] op_sel:[0,1,0] op_sel_hi:[1,1,0]
    v_pk_fma_f32 v[22:23], v[22:23], s[48:49], s[48:49] op_sel:[0,1,0] op_sel_hi:[1,1,0]
    v_readlane_b32 s74, v104, 8
    v_readlane_b32 s75, v120, 8
    s_waitcnt vmcnt(11)
    s_barrier
    v_pk_fma_f32 v[24:25], v[24:25], s[72:73], s[72:73] op_sel:[0,1,0] op_sel_hi:[1,1,0]
    v_pk_fma_f32 v[26:27], v[26:27], s[72:73], s[72:73] op_sel:[0,1,0] op_sel_hi:[1,1,0]
    ds_read_b64_tr_b16 a[0:1], v249 offset:0
    v_pk_fma_f32 v[28:29], v[28:29], s[72:73], s[72:73] op_sel:[0,1,0] op_sel_hi:[1,1,0]
    v_pk_fma_f32 v[30:31], v[30:31], s[72:73], s[72:73] op_sel:[0,1,0] op_sel_hi:[1,1,0]
    ds_read_b64_tr_b16 a[2:3], v249 offset:6144
    v_readlane_b32 s48, v104, 40
    v_readlane_b32 s49, v120, 40
    ds_read_b64_tr_b16 a[4:5], v249 offset:1024
    v_pk_fma_f32 v[32:33], v[32:33], s[74:75], s[74:75] op_sel:[0,1,0] op_sel_hi:[1,1,0]
    v_pk_fma_f32 v[34:35], v[34:35], s[74:75], s[74:75] op_sel:[0,1,0] op_sel_hi:[1,1,0]
    buffer_load_dwordx4 v246, s[8:11], s51 offen offset:1024 lds
    v_pk_fma_f32 v[36:37], v[36:37], s[74:75], s[74:75] op_sel:[0,1,0] op_sel_hi:[1,1,0]
    ds_read_b64_tr_b16 a[6:7], v249 offset:7168
    v_pk_fma_f32 v[38:39], v[38:39], s[74:75], s[74:75] op_sel:[0,1,0] op_sel_hi:[1,1,0]
    v_readlane_b32 s72, v104, 24
    ds_read_b64_tr_b16 a[8:9], v249 offset:2048
    v_readlane_b32 s73, v120, 24
    v_pk_fma_f32 v[40:41], v[40:41], s[48:49], s[48:49] op_sel:[0,1,0] op_sel_hi:[1,1,0]
    ds_read_b64_tr_b16 a[10:11], v249 offset:8192
    v_pk_fma_f32 v[42:43], v[42:43], s[48:49], s[48:49] op_sel:[0,1,0] op_sel_hi:[1,1,0]
    v_pk_fma_f32 v[44:45], v[44:45], s[48:49], s[48:49] op_sel:[0,1,0] op_sel_hi:[1,1,0]
    ds_read_b64_tr_b16 a[12:13], v249 offset:12288
    v_pk_fma_f32 v[46:47], v[46:47], s[48:49], s[48:49] op_sel:[0,1,0] op_sel_hi:[1,1,0]
    v_readlane_b32 s74, v104, 56
    v_readlane_b32 s75, v120, 56
    ds_read_b64_tr_b16 a[14:15], v249 offset:18432
    v_pk_fma_f32 v[48:49], v[48:49], s[72:73], s[72:73] op_sel:[0,1,0] op_sel_hi:[1,1,0]
    v_pk_fma_f32 v[50:51], v[50:51], s[72:73], s[72:73] op_sel:[0,1,0] op_sel_hi:[1,1,0]
    buffer_load_dwordx4 v246, s[8:11], s51 offen offset:2048 lds
    s_add_u32 s51, s51, 98304
    ds_read_b64_tr_b16 a[16:17], v249 offset:13312
    v_pk_fma_f32 v[52:53], v[52:53], s[72:73], s[72:73] op_sel:[0,1,0] op_sel_hi:[1,1,0]
    v_pk_fma_f32 v[54:55], v[54:55], s[72:73], s[72:73] op_sel:[0,1,0] op_sel_hi:[1,1,0]
    ds_read_b64_tr_b16 a[18:19], v249 offset:19456
    v_readlane_b32 s48, v104, 4
    v_readlane_b32 s49, v120, 4
    v_pk_fma_f32 v[56:57], v[56:57], s[74:75], s[74:75] op_sel:[0,1,0] op_sel_hi:[1,1,0]
    ds_read_b64_tr_b16 a[20:21], v249 offset:14336
    v_pk_fma_f32 v[58:59], v[58:59], s[74:75], s[74:75] op_sel:[0,1,0] op_sel_hi:[1,1,0]
    v_pk_fma_f32 v[60:61], v[60:61], s[74:75], s[74:75] op_sel:[0,1,0] op_sel_hi:[1,1,0]
    ds_read_b64_tr_b16 a[22:23], v249 offset:20480
    v_pk_fma_f32 v[62:63], v[62:63], s[74:75], s[74:75] op_sel:[0,1,0] op_sel_hi:[1,1,0]
    v_readlane_b32 s72, v104, 36
    ds_read_b64_tr_b16 a[24:25], v249 offset:24576
    v_readlane_b32 s73, v120, 36
    v_pk_fma_f32 v[64:65], v[64:65], s[48:49], s[48:49] op_sel:[0,1,0] op_sel_hi:[1,1,0]
    ds_read_b64_tr_b16 a[26:27], v249 offset:30720
    v_pk_fma_f32 v[66:67], v[66:67], s[48:49], s[48:49] op_sel:[0,1,0] op_sel_hi:[1,1,0]
    s_bfm_b64 exec, 11, 0
    s_mul_i32 s56, s79, 1408
    buffer_load_dword v227, v247, s[20:23], s56 offen offset:0
    s_mov_b64 exec, -1
    v_pk_fma_f32 v[68:69], v[68:69], s[48:49], s[48:49] op_sel:[0,1,0] op_sel_hi:[1,1,0]
    v_pk_fma_f32 v[70:71], v[70:71], s[48:49], s[48:49] op_sel:[0,1,0] op_sel_hi:[1,1,0]
    ds_read_b64_tr_b16 a[28:29], v249 offset:25600
    v_readlane_b32 s74, v104, 20
    v_readlane_b32 s75, v120, 20
    ds_read_b64_tr_b16 a[30:31], v249 offset:31744
    v_pk_fma_f32 v[72:73], v[72:73], s[72:73], s[72:73] op_sel:[0,1,0] op_sel_hi:[1,1,0]
    v_pk_fma_f32 v[74:75], v[74:75], s[72:73], s[72:73] op_sel:[0,1,0] op_sel_hi:[1,1,0]
    ds_read_b64_tr_b16 a[32:33], v249 offset:26624
    v_pk_fma_f32 v[76:77], v[76:77], s[72:73], s[72:73] op_sel:[0,1,0] op_sel_hi:[1,1,0]
    v_pk_fma_f32 v[78:79], v[78:79], s[72:73], s[72:73] op_sel:[0,1,0] op_sel_hi:[1,1,0]
    v_readlane_b32 s48, v104, 52
    ds_read_b64_tr_b16 a[34:35], v249 offset:32768
    v_readlane_b32 s49, v120, 52
    v_pk_fma_f32 v[80:81], v[80:81], s[74:75], s[74:75] op_sel:[0,1,0] op_sel_hi:[1,1,0]
    ds_read_b64_tr_b16 a[36:37], v249 offset:36864
    v_pk_fma_f32 v[82:83], v[82:83], s[74:75], s[74:75] op_sel:[0,1,0] op_sel_hi:[1,1,0]
    s_bfm_b64 exec, 4, 0
    s_mul_i32 s56, s3, 4096
    buffer_load_dword v227, v223, s[12:15], s56 offen offset:384
    s_mov_b64 exec, -1
    v_pk_fma_f32 v[84:85], v[84:85], s[74:75], s[74:75] op_sel:[0,1,0] op_sel_hi:[1,1,0]
    ds_read_b64_tr_b16 a[38:39], v249 offset:43008
    v_pk_fma_f32 v[86:87], v[86:87], s[74:75], s[74:75] op_sel:[0,1,0] op_sel_hi:[1,1,0]
    v_readlane_b32 s72, v104, 12
    ds_read_b64_tr_b16 a[40:41], v249 offset:37888
    v_readlane_b32 s73, v120, 12
    v_pk_fma_f32 v[88:89], v[88:89], s[48:49], s[48:49] op_sel:[0,1,0] op_sel_hi:[1,1,0]
    v_pk_fma_f32 v[90:91], v[90:91], s[48:49], s[48:49] op_sel:[0,1,0] op_sel_hi:[1,1,0]
    ds_read_b64_tr_b16 a[42:43], v249 offset:44032
    v_pk_fma_f32 v[92:93], v[92:93], s[48:49], s[48:49] op_sel:[0,1,0] op_sel_hi:[1,1,0]
    v_pk_fma_f32 v[94:95], v[94:95], s[48:49], s[48:49] op_sel:[0,1,0] op_sel_hi:[1,1,0]
    ds_read_b64_tr_b16 a[44:45], v249 offset:38912
    v_pk_fma_f32 v[96:97], v[96:97], s[72:73], s[72:73] op_sel:[0,1,0] op_sel_hi:[1,1,0]
    v_pk_fma_f32 v[98:99], v[98:99], s[72:73], s[72:73] op_sel:[0,1,0] op_sel_hi:[1,1,0]
    ds_read_b64_tr_b16 a[46:47], v249 offset:45056
    v_pk_fma_f32 v[100:101], v[100:101], s[72:73], s[72:73] op_sel:[0,1,0] op_sel_hi:[1,1,0]
    v_pk_fma_f32 v[102:103], v[102:103], s[72:73], s[72:73] op_sel:[0,1,0] op_sel_hi:[1,1,0]
    s_waitcnt vmcnt(8)
    v_xor_b32 v189, s63, v188
    s_waitcnt vmcnt(7)
    v_xor_b32 v193, s63, v192
    s_waitcnt vmcnt(6)
    v_xor_b32 v197, s63, v196
    s_waitcnt vmcnt(5)
    v_xor_b32 v201, s63, v200
    v_or3_b32 v189, v189, v193, v197
    v_or_b32 v189, v189, v201
    v_cmp_ne_u32 vcc, 0, v189
    s_nop 1
    s_cbranch_vccnz L_PS_3
L_PD_2:
    v_and_b32 v189, 0xffff0000, v187
    v_lshlrev_b32 v188, 16, v187
    v_and_b32 v187, 0xffff0000, v186
    v_lshlrev_b32 v186, 16, v186
    v_and_b32 v193, 0xffff0000, v191
    v_lshlrev_b32 v192, 16, v191
    v_and_b32 v191, 0xffff0000, v190
    v_lshlrev_b32 v190, 16, v190
    v_and_b32 v197, 0xffff0000, v195
    v_lshlrev_b32 v196, 16, v195
    v_and_b32 v195, 0xffff0000, v194
    v_lshlrev_b32 v194, 16, v194
    v_and_b32 v201, 0xffff0000, v199
    v_lshlrev_b32 v200, 16, v199
    v_and_b32 v199, 0xffff0000, v198
    v_lshlrev_b32 v198, 16, v198
    v_pk_fma_f32 v[96:97], v[96:97], v[194:195], v[186:187]
    v_pk_fma_f32 v[98:99], v[98:99], v[196:197], v[188:189]
    v_pk_fma_f32 v[100:101], v[100:101], v[198:199], v[190:191]
    v_pk_fma_f32 v[102:103], v[102:103], v[200:201], v[192:193]
    v_cvt_pk_bf16_f32 v96, v96, v97
    v_cvt_pk_bf16_f32 v97, v98, v99
    v_cvt_pk_bf16_f32 v98, v100, v101
    v_cvt_pk_bf16_f32 v99, v102, v103
    buffer_store_dwordx4 v[96:99], v240, s[32:35], s82 offen sc1
    v_pk_fma_f32 v[0:1], v[0:1], v[194:195], v[186:187]
    v_pk_fma_f32 v[2:3], v[2:3], v[196:197], v[188:189]
    v_pk_fma_f32 v[4:5], v[4:5], v[198:199], v[190:191]
    v_pk_fma_f32 v[6:7], v[6:7], v[200:201], v[192:193]
    v_cvt_pk_bf16_f32 v0, v0, v1
    v_cvt_pk_bf16_f32 v1, v2, v3
    v_cvt_pk_bf16_f32 v2, v4, v5
    v_cvt_pk_bf16_f32 v3, v6, v7
    s_waitcnt lgkmcnt(0)
    s_barrier
    ds_write_b128 v164, v[0:3] offset:0
    s_add_u32 m0, s52, 12288
    s_nop 0
    buffer_load_dwordx4 v246, s[8:11], s51 offen offset:0 lds
    v_pk_fma_f32 v[8:9], v[8:9], v[194:195], v[186:187]
    v_pk_fma_f32 v[10:11], v[10:11], v[196:197], v[188:189]
    v_pk_fma_f32 v[12:13], v[12:13], v[198:199], v[190:191]
    v_pk_fma_f32 v[14:15], v[14:15], v[200:201], v[192:193]
    v_cvt_pk_bf16_f32 v8, v8, v9
    v_cvt_pk_bf16_f32 v9, v10, v11
    v_cvt_pk_bf16_f32 v10, v12, v13
    v_cvt_pk_bf16_f32 v11, v14, v15
    ds_write_b128 v164, v[8:11] offset:128
    v_pk_fma_f32 v[16:17], v[16:17], v[194:195], v[186:187]
    v_pk_fma_f32 v[18:19], v[18:19], v[196:197], v[188:189]
    v_pk_fma_f32 v[20:21], v[20:21], v[198:199], v[190:191]
    v_pk_fma_f32 v[22:23], v[22:23], v[200:201], v[192:193]
    v_cvt_pk_bf16_f32 v16, v16, v17
    v_cvt_pk_bf16_f32 v17, v18, v19
    v_cvt_pk_bf16_f32 v18, v20, v21
    buffer_load_dwordx4 v246, s[8:11], s51 offen offset:1024 lds
    v_cvt_pk_bf16_f32 v19, v22, v23
    ds_write_b128 v165, v[16:19] offset:256
    v_pk_fma_f32 v[24:25], v[24:25], v[194:195], v[186:187]
    v_pk_fma_f32 v[26:27], v[26:27], v[196:197], v[188:189]
    v_pk_fma_f32 v[28:29], v[28:29], v[198:199], v[190:191]
    v_pk_fma_f32 v[30:31], v[30:31], v[200:201], v[192:193]
    v_cvt_pk_bf16_f32 v24, v24, v25
    v_cvt_pk_bf16_f32 v25, v26, v27
    v_cvt_pk_bf16_f32 v26, v28, v29
    v_cvt_pk_bf16_f32 v27, v30, v31
    ds_write_b128 v165, v[24:27] offset:384
    v_pk_fma_f32 v[32:33], v[32:33], v[194:195], v[186:187]
    v_pk_fma_f32 v[34:35], v[34:35], v[196:197], v[188:189]
    v_pk_fma_f32 v[36:37], v[36:37], v[198:199], v[190:191]
    v_pk_fma_f32 v[38:39], v[38:39], v[200:201], v[192:193]
    v_cvt_pk_bf16_f32 v32, v32, v33
    v_cvt_pk_bf16_f32 v33, v34, v35
    buffer_load_dwordx4 v246, s[8:11], s51 offen offset:2048 lds
    s_add_u32 s51, s51, 98304
    v_cvt_pk_bf16_f32 v34, v36, v37
    v_cvt_pk_bf16_f32 v35, v38, v39
    ds_write_b128 v164, v[32:35] offset:2048
    v_pk_fma_f32 v[40:41], v[40:41], v[194:195], v[186:187]
    v_pk_fma_f32 v[42:43], v[42:43], v[196:197], v[188:189]
    v_pk_fma_f32 v[44:45], v[44:45], v[198:199], v[190:191]
    v_pk_fma_f32 v[46:47], v[46:47], v[200:201], v[192:193]
    v_cvt_pk_bf16_f32 v40, v40, v41
    v_cvt_pk_bf16_f32 v41, v42, v43
    v_cvt_pk_bf16_f32 v42, v44, v45
    v_cvt_pk_bf16_f32 v43, v46, v47
    ds_write_b128 v164, v[40:43] offset:4096
    v_pk_fma_f32 v[48:49], v[48:49], v[194:195], v[186:187]
    v_pk_fma_f32 v[50:51], v[50:51], v[196:197], v[188:189]
    v_pk_fma_f32 v[52:53], v[52:53], v[198:199], v[190:191]
    v_pk_fma_f32 v[54:55], v[54:55], v[200:201], v[192:193]
    s_add_u32 m0, s52, 24576
    s_nop 0
    buffer_load_dwordx4 v246, s[8:11], s51 offen offset:0 lds
    v_cvt_pk_bf16_f32 v48, v48, v49
    v_cvt_pk_bf16_f32 v49, v50, v51
    v_cvt_pk_bf16_f32 v50, v52, v53
    v_cvt_pk_bf16_f32 v51, v54, v55
    ds_write_b128 v164, v[48:51] offset:2176
    v_pk_fma_f32 v[56:57], v[56:57], v[194:195], v[186:187]
    v_pk_fma_f32 v[58:59], v[58:59], v[196:197], v[188:189]
    v_pk_fma_f32 v[60:61], v[60:61], v[198:199], v[190:191]
    v_pk_fma_f32 v[62:63], v[62:63], v[200:201], v[192:193]
    v_cvt_pk_bf16_f32 v56, v56, v57
    v_cvt_pk_bf16_f32 v57, v58, v59
    v_cvt_pk_bf16_f32 v58, v60, v61
    v_cvt_pk_bf16_f32 v59, v62, v63
    ds_write_b128 v164, v[56:59] offset:4224
    v_pk_fma_f32 v[64:65], v[64:65], v[194:195], v[186:187]
    v_pk_fma_f32 v[66:67], v[66:67], v[196:197], v[188:189]
    v_pk_fma_f32 v[68:69], v[68:69], v[198:199], v[190:191]
    buffer_load_dwordx4 v246, s[8:11], s51 offen offset:1024 lds
    v_pk_fma_f32 v[70:71], v[70:71], v[200:201], v[192:193]
    v_cvt_pk_bf16_f32 v64, v64, v65
    v_cvt_pk_bf16_f32 v65, v66, v67
    v_cvt_pk_bf16_f32 v66, v68, v69
    v_cvt_pk_bf16_f32 v67, v70, v71
    ds_write_b128 v165, v[64:67] offset:2304
    v_pk_fma_f32 v[72:73], v[72:73], v[194:195], v[186:187]
    v_pk_fma_f32 v[74:75], v[74:75], v[196:197], v[188:189]
    v_pk_fma_f32 v[76:77], v[76:77], v[198:199], v[190:191]
    v_pk_fma_f32 v[78:79], v[78:79], v[200:201], v[192:193]
    v_cvt_pk_bf16_f32 v72, v72, v73
    v_cvt_pk_bf16_f32 v73, v74, v75
    v_cvt_pk_bf16_f32 v74, v76, v77
    v_cvt_pk_bf16_f32 v75, v78, v79
    ds_write_b128 v165, v[72:75] offset:4352
    v_pk_fma_f32 v[80:81], v[80:81], v[194:195], v[186:187]
    buffer_load_dwordx4 v246, s[8:11], s51 offen offset:2048 lds
    s_add_u32 s51, s51, 98304
    v_pk_fma_f32 v[82:83], v[82:83], v[196:197], v[188:189]
    v_pk_fma_f32 v[84:85], v[84:85], v[198:199], v[190:191]
    v_pk_fma_f32 v[86:87], v[86:87], v[200:201], v[192:193]
    v_cvt_pk_bf16_f32 v80, v80, v81
    v_cvt_pk_bf16_f32 v81, v82, v83
    v_cvt_pk_bf16_f32 v82, v84, v85
    v_cvt_pk_bf16_f32 v83, v86, v87
    ds_write_b128 v165, v[80:83] offset:2432
    v_pk_fma_f32 v[88:89], v[88:89], v[194:195], v[186:187]
    v_pk_fma_f32 v[90:91], v[90:91], v[196:197], v[188:189]
    v_pk_fma_f32 v[92:93], v[92:93], v[198:199], v[190:191]
    v_pk_fma_f32 v[94:95], v[94:95], v[200:201], v[192:193]
    v_cvt_pk_bf16_f32 v88, v88, v89
    v_cvt_pk_bf16_f32 v89, v90, v91
    v_cvt_pk_bf16_f32 v90, v92, v93
    v_cvt_pk_bf16_f32 v91, v94, v95
    ds_write_b128 v165, v[88:91] offset:4480
    s_waitcnt vmcnt(6)
    s_mov_b64 exec, 2
    buffer_store_dword v254, v255, s[32:35], s58 offen offset:112
    s_mov_b64 exec, -1
    s_waitcnt lgkmcnt(0)
    s_barrier
    ds_read_b128 v[56:59], v235 offset:0
    ds_read_b128 v[60:63], v235 offset:2048
    ds_read_b128 v[64:67], v235 offset:4096
    ds_read_b128 v[68:71], v236 offset:0
    ds_read_b128 v[72:75], v236 offset:2048
    ds_read_b128 v[76:79], v236 offset:4096
    s_waitcnt lgkmcnt(5)
    v_mfma_f32_16x16x32_bf16 v[0:3], a[4:7], v[56:59], 0
    s_add_u32 m0, s52, 36864
    ds_read_b128 v[80:83], v235 offset:6144
    ds_read_b128 v[84:87], v235 offset:8192
    v_mfma_f32_16x16x32_bf16 v[12:15], v[56:59], a[8:11], 0
    buffer_load_dwordx4 v246, s[8:11], s51 offen offset:0 lds
    s_waitcnt lgkmcnt(6)
    v_mfma_f32_16x16x32_bf16 v[4:7], a[4:7], v[60:63], 0
    buffer_load_dwordx4 v246, s[8:11], s51 offen offset:1024 lds
    v_mfma_f32_16x16x32_bf16 v[16:19], v[60:63], a[8:11], 0
    ds_read_b64_tr_b16 a[48:49], v249 offset:49152
    ds_read_b64_tr_b16 a[50:51], v249 offset:55296
    v_mfma_f32_16x16x32_bf16 v[24:27], a[0:3], v[60:63], 0
    ds_read_b64_tr_b16 a[52:53], v249 offset:50176
    ds_read_b64_tr_b16 a[54:55], v249 offset:56320
    s_waitcnt lgkmcnt(9)
    v_mfma_f32_16x16x32_bf16 v[8:11], a[4:7], v[64:67], 0
    buffer_load_dwordx4 v246, s[8:11], s51 offen offset:2048 lds
    v_mfma_f32_16x16x32_bf16 v[20:23], v[64:67], a[8:11], 0
    s_add_u32 s51, s51, 98304
    ds_read_b128 v[88:91], v235 offset:10240
    ds_read_b64_tr_b16 a[56:57], v249 offset:51200
    v_mfma_f32_16x16x32_bf16 v[28:31], a[0:3], v[64:67], 0
    s_waitcnt lgkmcnt(8)
    ds_read_b64_tr_b16 a[58:59], v249 offset:57344
    v_add_u32 v220, 135168, v248
    v_mfma_f32_16x16x32_bf16 v[0:3], a[16:19], v[68:71], v[0:3]
    s_add_u32 m0, s52, 49152
    ds_read_b128 v[56:59], v236 offset:6144
    ds_read_b64_tr_b16 a[60:61], v220 offset:0
    v_mfma_f32_16x16x32_bf16 v[12:15], v[68:71], a[20:23], v[12:15]
    buffer_load_dwordx4 v246, s[8:11], s51 offen offset:0 lds
    v_mfma_f32_16x16x32_bf16 v[4:7], a[16:19], v[72:75], v[4:7]
    buffer_load_dwordx4 v246, s[8:11], s51 offen offset:1024 lds
    v_mfma_f32_16x16x32_bf16 v[16:19], v[72:75], a[20:23], v[16:19]
    ds_read_b64_tr_b16 a[62:63], v220 offset:6144
    ds_read_b64_tr_b16 a[64:65], v220 offset:1024
    v_mfma_f32_16x16x32_bf16 v[24:27], a[12:15], v[72:75], v[24:27]
    ds_read_b128 v[60:63], v236 offset:8192
    ds_read_b64_tr_b16 a[66:67], v220 offset:7168
    v_mfma_f32_16x16x32_bf16 v[8:11], a[16:19], v[76:79], v[8:11]
    buffer_load_dwordx4 v246, s[8:11], s51 offen offset:2048 lds
    v_mfma_f32_16x16x32_bf16 v[20:23], v[76:79], a[20:23], v[20:23]
    s_add_u32 s51, s51, 98304
    ds_read_b64_tr_b16 a[68:69], v220 offset:2048
    ds_read_b128 v[64:67], v236 offset:10240
    v_mfma_f32_16x16x32_bf16 v[28:31], a[12:15], v[76:79], v[28:31]
    s_waitcnt lgkmcnt(10)
    ds_read_b64_tr_b16 a[70:71], v220 offset:8192
    ds_read_b64_tr_b16 a[72:73], v248 offset:0
    v_mfma_f32_16x16x32_bf16 v[0:3], a[28:31], v[80:83], v[0:3]
    s_add_u32 m0, s52, 61440
    ds_read_b64_tr_b16 a[74:75], v248 offset:6144
    ds_read_b128 v[68:71], v235 offset:12288
    v_mfma_f32_16x16x32_bf16 v[12:15], v[80:83], a[32:35], v[12:15]
    buffer_load_dwordx4 v246, s[8:11], s51 offen offset:0 lds
    v_mfma_f32_16x16x32_bf16 v[4:7], a[28:31], v[84:87], v[4:7]
    buffer_load_dwordx4 v246, s[8:11], s51 offen offset:1024 lds
    v_mfma_f32_16x16x32_bf16 v[16:19], v[84:87], a[32:35], v[16:19]
    ds_read_b64_tr_b16 a[76:77], v248 offset:1024
    ds_read_b64_tr_b16 a[78:79], v248 offset:7168
    ds_read_b64_tr_b16 a[80:81], v248 offset:2048
    ds_read_b64_tr_b16 a[82:83], v248 offset:8192
    v_mfma_f32_16x16x32_bf16 v[24:27], a[24:27], v[84:87], v[24:27]
    ds_read_b128 v[72:75], v235 offset:14336
    ds_read_b128 v[76:79], v235 offset:16384
    v_mfma_f32_16x16x32_bf16 v[8:11], a[28:31], v[88:91], v[8:11]
    buffer_load_dwordx4 v246, s[8:11], s51 offen offset:2048 lds
    v_mfma_f32_16x16x32_bf16 v[20:23], v[88:91], a[32:35], v[20:23]
    s_add_u32 s51, s51, 98304
    v_mfma_f32_16x16x32_bf16 v[28:31], a[24:27], v[88:91], v[28:31]
    s_waitcnt lgkmcnt(10)
    v_mfma_f32_16x16x32_bf16 v[0:3], a[40:43], v[56:59], v[0:3]
    s_waitcnt vmcnt(10) lgkmcnt(2)
    s_barrier
    v_mfma_f32_16x16x32_bf16 v[12:15], v[56:59], a[44:47], v[12:15]
    ds_read_b128 v[80:83], v236 offset:12288
    ds_read_b128 v[84:87], v236 offset:14336
    v_mfma_f32_16x16x32_bf16 v[4:7], a[40:43], v[60:63], v[4:7]
    s_add_u32 m0, s52, 0
    ds_read_b128 v[88:91], v236 offset:16384
    v_mfma_f32_16x16x32_bf16 v[16:19], v[60:63], a[44:47], v[16:19]
    buffer_load_dwordx4 v246, s[8:11], s51 offen offset:0 lds
    v_mfma_f32_16x16x32_bf16 v[24:27], a[36:39], v[60:63], v[24:27]
    ds_read_b64_tr_b16 a[84:85], v248 offset:12288
    ds_read_b64_tr_b16 a[86:87], v248 offset:18432
    v_mfma_f32_16x16x32_bf16 v[8:11], a[40:43], v[64:67], v[8:11]
    ds_read_b64_tr_b16 a[88:89], v248 offset:13312
    ds_read_b64_tr_b16 a[90:91], v248 offset:19456
    v_mfma_f32_16x16x32_bf16 v[20:23], v[64:67], a[44:47], v[20:23]
    s_branch L_O1
.p2alignl 12, 0xbf810000
L_HN01:
    s_branch L_BN0
L_HU01:
    s_branch L_BU0
L_HL01:
    s_branch L_BL0
L_O1:
    ds_read_b64_tr_b16 a[92:93], v248 offset:14336
    ds_read_b64_tr_b16 a[94:95], v248 offset:20480
    v_mfma_f32_16x16x32_bf16 v[28:31], a[36:39], v[64:67], v[28:31]
    s_waitcnt lgkmcnt(9)
    ds_read_b64_tr_b16 a[96:97], v248 offset:24576
    ds_read_b64_tr_b16 a[98:99], v248 offset:30720
    v_mfma_f32_16x16x32_bf16 v[0:3], a[52:55], v[68:71], v[0:3]
    buffer_load_dwordx4 v246, s[8:11], s51 offen offset:1024 lds
    v_mfma_f32_16x16x32_bf16 v[12:15], v[68:71], a[56:59], v[12:15]
    ds_read_b128 v[56:59], v235 offset:18432
    ds_read_b64_tr_b16 a[100:101], v248 offset:25600
    v_mfma_f32_16x16x32_bf16 v[4:7], a[52:55], v[72:75], v[4:7]
    buffer_load_dwordx4 v246, s[8:11], s51 offen offset:2048 lds
    v_mfma_f32_16x16x32_bf16 v[16:19], v[72:75], a[56:59], v[16:19]
    ds_read_b64_tr_b16 a[102:103], v248 offset:31744
    ds_read_b128 v[60:63], v235 offset:20480
    ds_read_b64_tr_b16 a[104:105], v248 offset:26624
    ds_read_b64_tr_b16 a[106:107], v248 offset:32768
    v_mfma_f32_16x16x32_bf16 v[24:27], a[48:51], v[72:75], v[24:27]
    ds_read_b128 v[64:67], v235 offset:22528
    s_add_u32 s51, s51, 98304
    v_mfma_f32_16x16x32_bf16 v[8:11], a[52:55], v[76:79], v[8:11]
    v_mfma_f32_16x16x32_bf16 v[20:23], v[76:79], a[56:59], v[20:23]
    v_mfma_f32_16x16x32_bf16 v[28:31], a[48:51], v[76:79], v[28:31]
    s_waitcnt lgkmcnt(15)
    v_mfma_f32_16x16x32_bf16 v[0:3], a[64:67], v[80:83], v[0:3]
    s_waitcnt vmcnt(6) lgkmcnt(1)
    s_barrier
    v_mfma_f32_16x16x32_bf16 v[12:15], v[80:83], a[68:71], v[12:15]
    ds_read_b128 v[68:71], v236 offset:18432
    ds_read_b128 v[72:75], v236 offset:20480
    v_mfma_f32_16x16x32_bf16 v[4:7], a[64:67], v[84:87], v[4:7]
    s_add_u32 m0, s52, 12288
    ds_read_b128 v[76:79], v236 offset:22528
    v_mfma_f32_16x16x32_bf16 v[16:19], v[84:87], a[68:71], v[16:19]
    buffer_load_dwordx4 v246, s[8:11], s51 offen offset:0 lds
    v_mfma_f32_16x16x32_bf16 v[24:27], a[60:63], v[84:87], v[24:27]
    ds_read_b64_tr_b16 a[108:109], v248 offset:36864
    ds_read_b64_tr_b16 a[110:111], v248 offset:43008
    v_mfma_f32_16x16x32_bf16 v[8:11], a[64:67], v[88:91], v[8:11]
    buffer_load_dwordx4 v246, s[8:11], s51 offen offset:1024 lds
    v_mfma_f32_16x16x32_bf16 v[20:23], v[88:91], a[68:71], v[20:23]
    ds_read_b64_tr_b16 a[112:113], v248 offset:37888
    ds_read_b64_tr_b16 a[114:115], v248 offset:44032
    v_mfma_f32_16x16x32_bf16 v[28:31], a[60:63], v[88:91], v[28:31]
    s_waitcnt lgkmcnt(7)
    ds_read_b64_tr_b16 a[116:117], v248 offset:38912
    ds_read_b64_tr_b16 a[118:119], v248 offset:45056
    v_mfma_f32_16x16x32_bf16 v[0:3], a[76:79], v[56:59], v[0:3]
    buffer_load_dwordx4 v246, s[8:11], s51 offen offset:2048 lds
    v_mfma_f32_16x16x32_bf16 v[12:15], v[56:59], a[80:83], v[12:15]
    ds_read_b128 v[80:83], v235 offset:24576
    ds_read_b128 v[84:87], v235 offset:26624
    v_mfma_f32_16x16x32_bf16 v[4:7], a[76:79], v[60:63], v[4:7]
    buffer_load_dword v239, v228, s[32:35], s59 offen offset:128 sc1
    v_mfma_f32_16x16x32_bf16 v[16:19], v[60:63], a[80:83], v[16:19]
    s_add_u32 s51, s51, 98304
    ds_read_b64_tr_b16 a[120:121], v248 offset:49152
    ds_read_b128 v[88:91], v235 offset:28672
    v_mfma_f32_16x16x32_bf16 v[24:27], a[72:75], v[60:63], v[24:27]
    s_add_u32 m0, s52, 24576
    ds_read_b64_tr_b16 a[122:123], v248 offset:55296
    ds_read_b64_tr_b16 a[124:125], v248 offset:50176
    v_mfma_f32_16x16x32_bf16 v[8:11], a[76:79], v[64:67], v[8:11]
    buffer_load_dwordx4 v246, s[8:11], s51 offen offset:0 lds
    v_mfma_f32_16x16x32_bf16 v[20:23], v[64:67], a[80:83], v[20:23]
    ds_read_b64_tr_b16 a[126:127], v248 offset:56320
    ds_read_b64_tr_b16 a[128:129], v248 offset:51200
    v_mfma_f32_16x16x32_bf16 v[28:31], a[72:75], v[64:67], v[28:31]
    s_waitcnt lgkmcnt(14)
    ds_read_b64_tr_b16 a[130:131], v248 offset:57344
    v_mfma_f32_16x16x32_bf16 v[0:3], a[88:91], v[68:71], v[0:3]
    buffer_load_dwordx4 v246, s[8:11], s51 offen offset:1024 lds
    v_mfma_f32_16x16x32_bf16 v[12:15], v[68:71], a[92:95], v[12:15]
    ds_read_b128 v[56:59], v236 offset:24576
    ds_read_b128 v[60:63], v236 offset:26624
    v_mfma_f32_16x16x32_bf16 v[4:7], a[88:91], v[72:75], v[4:7]
    ds_read_b128 v[64:67], v236 offset:28672
    v_mfma_f32_16x16x32_bf16 v[16:19], v[72:75], a[92:95], v[16:19]
    buffer_load_dwordx4 v246, s[8:11], s51 offen offset:2048 lds
    v_mfma_f32_16x16x32_bf16 v[24:27], a[84:87], v[72:75], v[24:27]
    s_add_u32 s51, s51, 98304
    v_mfma_f32_16x16x32_bf16 v[8:11], a[88:91], v[76:79], v[8:11]
    v_mfma_f32_16x16x32_bf16 v[20:23], v[76:79], a[92:95], v[20:23]
    v_mfma_f32_16x16x32_bf16 v[28:31], a[84:87], v[76:79], v[28:31]
    s_waitcnt lgkmcnt(8)
    v_mfma_f32_16x16x32_bf16 v[0:3], a[100:103], v[80:83], v[0:3]
    s_waitcnt vmcnt(7) lgkmcnt(3)
    s_barrier
    v_mfma_f32_16x16x32_bf16 v[12:15], v[80:83], a[104:107], v[12:15]
    ds_read_b128 v[68:71], v235 offset:30720
    ds_read_b128 v[72:75], v235 offset:32768
    v_mfma_f32_16x16x32_bf16 v[4:7], a[100:103], v[84:87], v[4:7]
    s_add_u32 m0, s52, 36864
    ds_read_b128 v[76:79], v235 offset:34816
    v_mfma_f32_16x16x32_bf16 v[16:19], v[84:87], a[104:107], v[16:19]
    buffer_load_dwordx4 v246, s[8:11], s51 offen offset:0 lds
    v_mfma_f32_16x16x32_bf16 v[24:27], a[96:99], v[84:87], v[24:27]
    v_add_u32 v220, 61440, v248
    ds_read_b64_tr_b16 a[132:133], v220 offset:0
    v_mfma_f32_16x16x32_bf16 v[8:11], a[100:103], v[88:91], v[8:11]
    buffer_load_dwordx4 v246, s[8:11], s51 offen offset:1024 lds
    v_mfma_f32_16x16x32_bf16 v[20:23], v[88:91], a[104:107], v[20:23]
    ds_read_b64_tr_b16 a[134:135], v220 offset:6144
    ds_read_b64_tr_b16 a[136:137], v220 offset:1024
    v_mfma_f32_16x16x32_bf16 v[28:31], a[96:99], v[88:91], v[28:31]
    s_waitcnt lgkmcnt(6)
    ds_read_b64_tr_b16 a[138:139], v220 offset:7168
    ds_read_b64_tr_b16 a[140:141], v220 offset:2048
    v_mfma_f32_16x16x32_bf16 v[0:3], a[112:115], v[56:59], v[0:3]
    buffer_load_dwordx4 v246, s[8:11], s51 offen offset:2048 lds
    v_mfma_f32_16x16x32_bf16 v[12:15], v[56:59], a[116:119], v[12:15]
    ds_read_b128 v[80:83], v236 offset:30720
    ds_read_b128 v[84:87], v236 offset:32768
    v_mfma_f32_16x16x32_bf16 v[4:7], a[112:115], v[60:63], v[4:7]
    ds_read_b64_tr_b16 a[142:143], v220 offset:8192
    ds_read_b64_tr_b16 a[144:145], v248 offset:0
    v_mfma_f32_16x16x32_bf16 v[16:19], v[60:63], a[116:119], v[16:19]
    ds_read_b128 v[88:91], v236 offset:34816
    ds_read_b64_tr_b16 a[146:147], v248 offset:6144
    v_mfma_f32_16x16x32_bf16 v[24:27], a[108:111], v[60:63], v[24:27]
    ds_read_b64_tr_b16 a[148:149], v248 offset:1024
    ds_read_b64_tr_b16 a[150:151], v248 offset:7168
    v_mfma_f32_16x16x32_bf16 v[8:11], a[112:115], v[64:67], v[8:11]
    ds_read_b64_tr_b16 a[152:153], v248 offset:2048
    ds_read_b64_tr_b16 a[154:155], v248 offset:8192
    v_mfma_f32_16x16x32_bf16 v[20:23], v[64:67], a[116:119], v[20:23]
    v_mfma_f32_16x16x32_bf16 v[28:31], a[108:111], v[64:67], v[28:31]
    s_waitcnt vmcnt(6) lgkmcnt(15)
    v_cmp_ne_u32 vcc, s96, v239
    s_nop 1
    s_cbranch_vccnz L_WS_7
L_WD_6:
    v_mfma_f32_16x16x32_bf16 v[0:3], a[124:127], v[68:71], v[0:3]
    s_add_u32 m0, s84, 122880
    ds_read_b128 v[56:59], v235 offset:36864
    ds_read_b128 v[60:63], v235 offset:38912
    v_mfma_f32_16x16x32_bf16 v[12:15], v[68:71], a[128:131], v[12:15]
    buffer_load_dwordx4 v255, s[32:35], s101 offen offset:0 sc1 lds
    v_mfma_f32_16x16x32_bf16 v[4:7], a[124:127], v[72:75], v[4:7]
    buffer_load_dwordx4 v255, s[32:35], s101 offen offset:1024 sc1 lds
    v_mfma_f32_16x16x32_bf16 v[16:19], v[72:75], a[128:131], v[16:19]
    ds_read_b128 v[64:67], v235 offset:40960
    v_mfma_f32_16x16x32_bf16 v[24:27], a[120:123], v[72:75], v[24:27]
    v_mfma_f32_16x16x32_bf16 v[8:11], a[124:127], v[76:79], v[8:11]
    buffer_load_dwordx4 v255, s[32:35], s101 offen offset:2048 sc1 lds
    v_mfma_f32_16x16x32_bf16 v[20:23], v[76:79], a[128:131], v[20:23]
    v_mfma_f32_16x16x32_bf16 v[28:31], a[120:123], v[76:79], v[28:31]
    s_waitcnt lgkmcnt(8)
    v_mfma_f32_16x16x32_bf16 v[0:3], a[136:139], v[80:83], v[0:3]
    s_waitcnt vmcnt(6) lgkmcnt(3)
    s_barrier
    v_mfma_f32_16x16x32_bf16 v[12:15], v[80:83], a[140:143], v[12:15]
    buffer_load_dwordx4 v255, s[32:35], s101 offen offset:3072 sc1 lds
    v_mfma_f32_16x16x32_bf16 v[4:7], a[136:139], v[84:87], v[4:7]
    s_add_u32 s101, s101, 4096
    ds_read_b128 v[68:71], v236 offset:36864
    ds_read_b128 v[72:75], v236 offset:38912
    v_mfma_f32_16x16x32_bf16 v[16:19], v[84:87], a[140:143], v[16:19]
    s_add_u32 m0, s84, 126976
    ds_read_b64_tr_b16 a[156:157], v248 offset:12288
    ds_read_b64_tr_b16 a[158:159], v248 offset:18432
    v_mfma_f32_16x16x32_bf16 v[24:27], a[132:135], v[84:87], v[24:27]
    buffer_load_dwordx4 v255, s[32:35], s101 offen offset:0 sc1 lds
    v_mfma_f32_16x16x32_bf16 v[8:11], a[136:139], v[88:91], v[8:11]
    ds_read_b64_tr_b16 a[160:161], v248 offset:13312
    ds_read_b128 v[76:79], v236 offset:40960
    v_mfma_f32_16x16x32_bf16 v[20:23], v[88:91], a[140:143], v[20:23]
    ds_read_b64_tr_b16 a[162:163], v248 offset:19456
    ds_read_b64_tr_b16 a[164:165], v248 offset:14336
    v_mfma_f32_16x16x32_bf16 v[28:31], a[132:135], v[88:91], v[28:31]
    s_waitcnt lgkmcnt(8)
    ds_read_b64_tr_b16 a[166:167], v248 offset:20480
    ds_read_b64_tr_b16 a[168:169], v248 offset:24576
    v_mfma_f32_16x16x32_bf16 v[0:3], a[148:151], v[56:59], v[0:3]
    buffer_load_dwordx4 v255, s[32:35], s101 offen offset:1024 sc1 lds
    v_mfma_f32_16x16x32_bf16 v[12:15], v[56:59], a[152:155], v[12:15]
    ds_read_b128 v[80:83], v235 offset:43008
    ds_read_b64_tr_b16 a[170:171], v248 offset:30720
    v_mfma_f32_16x16x32_bf16 v[4:7], a[148:151], v[60:63], v[4:7]
    buffer_load_dwordx4 v255, s[32:35], s101 offen offset:2048 sc1 lds
    v_mfma_f32_16x16x32_bf16 v[16:19], v[60:63], a[152:155], v[16:19]
    ds_read_b64_tr_b16 a[172:173], v248 offset:25600
    ds_read_b64_tr_b16 a[174:175], v248 offset:31744
    ds_read_b64_tr_b16 a[176:177], v248 offset:26624
    ds_read_b64_tr_b16 a[178:179], v248 offset:32768
    v_mfma_f32_16x16x32_bf16 v[24:27], a[144:147], v[60:63], v[24:27]
    ds_read_b128 v[84:87], v235 offset:45056
    ds_read_b128 v[88:91], v235 offset:47104
    v_mfma_f32_16x16x32_bf16 v[8:11], a[148:151], v[64:67], v[8:11]
    buffer_load_dwordx4 v255, s[32:35], s101 offen offset:3072 sc1 lds
    v_mfma_f32_16x16x32_bf16 v[20:23], v[64:67], a[152:155], v[20:23]
    v_mfma_f32_16x16x32_bf16 v[28:31], a[144:147], v[64:67], v[28:31]
    s_waitcnt lgkmcnt(11)
    v_mfma_f32_16x16x32_bf16 v[0:3], a[160:163], v[68:71], v[0:3]
    s_waitcnt vmcnt(8) lgkmcnt(2)
    s_barrier
    v_mfma_f32_16x16x32_bf16 v[12:15], v[68:71], a[164:167], v[12:15]
    s_lshl_b32 s51, s60, 17
    s_lshl_b32 s57, s62, 7
    ds_read_b128 v[56:59], v236 offset:43008
    v_mfma_f32_16x16x32_bf16 v[4:7], a[160:163], v[72:75], v[4:7]
    s_add_u32 s51, s51, s57
    ds_read_b128 v[60:63], v236 offset:45056
    ds_read_b128 v[64:67], v236 offset:47104
    v_mfma_f32_16x16x32_bf16 v[16:19], v[72:75], a[164:167], v[16:19]
    buffer_load_dwordx4 v[92:95], v255, s[32:35], s99 offen offset:0 sc1
    v_mfma_f32_16x16x32_bf16 v[24:27], a[156:159], v[72:75], v[24:27]
    buffer_load_dwordx4 v[96:99], v255, s[32:35], s100 offen offset:0 sc1
    v_mfma_f32_16x16x32_bf16 v[8:11], a[160:163], v[76:79], v[8:11]
    ds_read_b64_tr_b16 a[180:181], v248 offset:36864
    ds_read_b64_tr_b16 a[182:183], v248 offset:43008
    v_mfma_f32_16x16x32_bf16 v[20:23], v[76:79], a[164:167], v[20:23]
    buffer_load_dwordx4 v[206:209], v234, s[4:7], s42 offen
    v_mfma_f32_16x16x32_bf16 v[28:31], a[156:159], v[76:79], v[28:31]
    s_waitcnt lgkmcnt(5)
    ds_read_b64_tr_b16 a[184:185], v248 offset:37888
    ds_read_b64_tr_b16 a[186:187], v248 offset:44032
    v_mfma_f32_16x16x32_bf16 v[0:3], a[172:175], v[80:83], v[0:3]
    buffer_load_dwordx4 v[210:213], v234, s[4:7], s43 offen
    v_mfma_f32_16x16x32_bf16 v[12:15], v[80:83], a[176:179], v[12:15]
    ds_read_b64_tr_b16 a[188:189], v248 offset:38912
    ds_read_b64_tr_b16 a[190:191], v248 offset:45056
    v_mfma_f32_16x16x32_bf16 v[4:7], a[172:175], v[84:87], v[4:7]
    s_cmp_eq_u32 s58, s59
    s_cbranch_scc1 L_SD_4
L_SX_5:
    s_add_u32 m0, s53, 0
    v_mfma_f32_16x16x32_bf16 v[16:19], v[84:87], a[176:179], v[16:19]
    v_mfma_f32_16x16x32_bf16 v[24:27], a[168:171], v[84:87], v[24:27]
    v_mfma_f32_16x16x32_bf16 v[8:11], a[172:175], v[88:91], v[8:11]
    buffer_load_dwordx4 v250, s[12:15], s51 offen offset:0 lds
    v_mfma_f32_16x16x32_bf16 v[20:23], v[88:91], a[176:179], v[20:23]
    v_mfma_f32_16x16x32_bf16 v[28:31], a[168:171], v[88:91], v[28:31]
    s_waitcnt lgkmcnt(2)
    v_mfma_f32_16x16x32_bf16 v[0:3], a[184:187], v[56:59], v[0:3]
    buffer_load_dwordx4 v251, s[12:15], s51 offen offset:1024 lds
    s_waitcnt lgkmcnt(0)
    s_barrier
    v_mfma_f32_16x16x32_bf16 v[12:15], v[56:59], a[188:191], v[12:15]
    buffer_load_dwordx4 v252, s[12:15], s51 offen offset:2048 lds
    v_mfma_f32_16x16x32_bf16 v[4:7], a[184:187], v[60:63], v[4:7]
    v_mfma_f32_16x16x32_bf16 v[16:19], v[60:63], a[188:191], v[16:19]
    v_mfma_f32_16x16x32_bf16 v[24:27], a[180:183], v[60:63], v[24:27]
    buffer_load_dwordx4 v253, s[12:15], s51 offen offset:3072 lds
    v_mfma_f32_16x16x32_bf16 v[8:11], a[184:187], v[64:67], v[8:11]
    s_add_u32 s51, s51, 32768
    v_mfma_f32_16x16x32_bf16 v[20:23], v[64:67], a[188:191], v[20:23]
    v_mfma_f32_16x16x32_bf16 v[28:31], a[180:183], v[64:67], v[28:31]
    v_cvt_pk_bf16_f32 v104, v0, v1
    s_add_u32 m0, s53, 16384
    s_nop 0
    buffer_load_dwordx4 v250, s[12:15], s51 offen offset:0 lds
    v_cvt_pk_bf16_f32 v105, v2, v3
    v_cvt_pk_bf16_f32 v106, v4, v5
    v_cvt_pk_bf16_f32 v107, v6, v7
    v_cvt_pk_bf16_f32 v124, v24, v25
    v_cvt_pk_bf16_f32 v125, v26, v27
    v_cvt_pk_bf16_f32 v108, v8, v9
    v_cvt_pk_bf16_f32 v109, v10, v11
    v_cvt_pk_bf16_f32 v126, v28, v29
    v_cvt_pk_bf16_f32 v127, v30, v31
    v_mfma_f32_16x16x16_bf16 v[128:131], v[104:105], v[124:125], v[174:177]
    buffer_load_dwordx4 v251, s[12:15], s51 offen offset:1024 lds
    v_mfma_f32_16x16x16_bf16 v[136:139], v[106:107], v[124:125], v[166:169]
    v_mfma_f32_16x16x16_bf16 v[132:135], v[104:105], v[126:127], v[178:181]
    v_mfma_f32_16x16x16_bf16 v[140:143], v[108:109], v[126:127], v[166:169]
    v_cvt_pk_bf16_f32 v118, v12, v13
    v_cvt_pk_bf16_f32 v119, v14, v15
    v_cvt_pk_bf16_f32 v120, v16, v17
    v_cvt_pk_bf16_f32 v121, v18, v19
    v_cvt_pk_bf16_f32 v116, v20, v21
    v_cvt_pk_bf16_f32 v117, v22, v23
    s_lshr_b32 s66, s60, 1
    s_lshl_b32 s66, s66, 10
    buffer_load_dwordx4 v252, s[12:15], s51 offen offset:2048 lds
    s_and_b32 s64, s60, 1
    v_max_f32 v128, v128, v136
    v_max_f32 v129, v129, v137
    v_max_f32 v130, v130, v138
    v_max_f32 v131, v131, v139
    v_max3_f32 v144, v128, v129, v130
    v_max_f32 v144, v144, v131
    v_max_f32 v132, v132, v140
    v_max_f32 v133, v133, v141
    v_max_f32 v134, v134, v142
    v_max_f32 v135, v135, v143
    buffer_load_dwordx4 v253, s[12:15], s51 offen offset:3072 lds
    s_add_u32 s51, s51, 32768
    v_max3_f32 v145, v132, v133, v134
    v_max_f32 v145, v145, v135
    s_lshl3_add_u32 s66, s64, s66
    s_add_u32 s66, s66, 155648
    v_add_u32 v160, s66, v255
    v_permlane32_swap_b32 v144, v145
    v_max_f32 v144, v144, v145
    v_mov_b32 v145, v144
    s_mul_i32 s72, s60, 4096
    s_add_u32 s72, s72, s47
    s_add_u32 s72, s72, 0
    s_add_u32 m0, s53, 32768
    s_nop 0
    buffer_load_dwordx4 v250, s[12:15], s51 offen offset:0 lds
    v_permlane16_swap_b32 v144, v145
    v_max_f32 v144, v144, v145
    v_mul_f32 v146, 0xbeb8aa3b, v144
    v_mul_f32 v144, 0xbeb8aa3b, v144
    s_lshr_b32 s74, s60, 1
    s_mul_i32 s74, s74, 16384
    s_add_u32 s73, s72, s74
    v_permlane32_swap_b32 v144, v146
    v_pk_fma_f32 v[128:129], v[128:129], s[44:45], v[144:145] op_sel_hi:[1,1,0]
    v_pk_fma_f32 v[130:131], v[130:131], s[44:45], v[144:145] op_sel_hi:[1,1,0]
    v_pk_fma_f32 v[132:133], v[132:133], s[44:45], v[146:147] op_sel_hi:[1,1,0]
    buffer_load_dwordx4 v251, s[12:15], s51 offen offset:1024 lds
    v_pk_fma_f32 v[134:135], v[134:135], s[44:45], v[146:147] op_sel_hi:[1,1,0]
    v_exp_f32 v128, v128
    v_exp_f32 v129, v129
    v_exp_f32 v130, v130
    v_exp_f32 v131, v131
    v_cvt_pk_bf16_f32 v156, v128, v129
    s_waitcnt vmcnt(14)
    s_barrier
    v_cvt_pk_bf16_f32 v157, v130, v131
    v_bfi_b32 v148, v182, 0, v156
    v_and_b32 v150, v182, v156
    v_bfi_b32 v149, v183, 0, v157
    v_and_b32 v151, v183, v157
    buffer_load_dwordx4 v252, s[12:15], s51 offen offset:2048 lds
    v_exp_f32 v132, v132
    v_exp_f32 v133, v133
    ds_read_b128 v[68:71], v237 offset:0
    v_exp_f32 v134, v134
    v_exp_f32 v135, v135
    v_mfma_f32_16x16x16_bf16 v[136:139], v[184:185], v[156:157], 0
    v_mfma_f32_16x16x32_bf16 v[128:131], v[118:121], v[148:151], 0
    v_cvt_pk_bf16_f32 v158, v132, v133
    v_cvt_pk_bf16_f32 v159, v134, v135
    v_bfi_b32 v154, v182, 0, v158
    v_and_b32 v152, v182, v158
    ds_read_b128 v[72:75], v237 offset:2048
    v_bfi_b32 v155, v183, 0, v159
    buffer_load_dwordx4 v253, s[12:15], s51 offen offset:3072 lds
    s_add_u32 s51, s51, 32768
    v_and_b32 v153, v183, v159
    v_rcp_f32 v136, v136
    v_mfma_f32_16x16x16_bf16 v[140:143], v[184:185], v[158:159], 0
    v_mfma_f32_16x16x32_bf16 v[132:135], v[116:119], v[152:155], 0
    v_pk_mul_f32 v[128:129], v[128:129], v[136:137] op_sel_hi:[1,0]
    v_pk_mul_f32 v[130:131], v[130:131], v[136:137] op_sel_hi:[1,0]
    ds_read_b128 v[80:83], v238 offset:0
    v_cvt_pk_bf16_f32 v124, v128, v129
    v_cvt_pk_bf16_f32 v125, v130, v131
    s_sub_u32 s72, s72, s74
    s_add_u32 s72, s72, 16384
    s_add_u32 s74, s72, 32768
    s_add_u32 m0, s52, 73728
    s_nop 0
    buffer_load_dwordx4 v245, s[16:19], s54 offen offset:0 lds
    v_rcp_f32 v140, v140
    s_nop 0
    v_pk_mul_f32 v[132:133], v[132:133], v[140:141] op_sel_hi:[1,0]
    v_pk_mul_f32 v[134:135], v[134:135], v[140:141] op_sel_hi:[1,0]
    ds_read_b128 v[84:87], v238 offset:2048
    v_cvt_pk_bf16_f32 v126, v132, v133
    v_cvt_pk_bf16_f32 v127, v134, v135
    s_add_u32 s75, s73, 32768
    v_permlane16_swap_b32 v124, v126
    v_permlane16_swap_b32 v125, v127
    buffer_store_dwordx4 v[124:127], v233, s[32:35], s80 offen sc1
    s_add_u32 s80, s80, 32768
    s_waitcnt lgkmcnt(3)
    v_mfma_f32_16x16x32_bf16 v[32:35], a[4:7], v[68:71], 0
    s_add_u32 m0, s52, 74624
    ds_read_b128 v[56:59], v237 offset:4096
    s_waitcnt vmcnt(17)
    v_xor_b32 v95, s63, v94
    v_mfma_f32_16x16x32_bf16 v[40:43], v[68:71], a[8:11], 0
    buffer_load_dwordx4 v245, s[16:19], s54 offen offset:128 lds
    v_mfma_f32_16x16x32_bf16 v[48:51], a[0:3], v[68:71], 0
    ds_read_b128 v[60:63], v237 offset:6144
    s_waitcnt vmcnt(17)
    v_xor_b32 v99, s63, v98
    s_waitcnt lgkmcnt(4)
    v_mfma_f32_16x16x32_bf16 v[36:39], a[4:7], v[72:75], 0
    s_add_u32 m0, s52, 75776
    v_or_b32 v95, v95, v99
    v_mfma_f32_16x16x32_bf16 v[44:47], v[72:75], a[8:11], 0
    v_cmp_ne_u32 vcc, 0, v95
    s_nop 1
    s_cbranch_vccnz L_PS_14
L_PD_13:
    v_mfma_f32_16x16x32_bf16 v[52:55], a[0:3], v[72:75], 0
    s_waitcnt lgkmcnt(2)
    v_mfma_f32_16x16x32_bf16 v[32:35], a[16:19], v[80:83], v[32:35]
    buffer_load_dwordx4 v244, s[16:19], s54 offen offset:0 lds
    v_mfma_f32_16x16x32_bf16 v[40:43], v[80:83], a[20:23], v[40:43]
    s_add_u32 s54, s54, 88064
    ds_read_b128 v[68:71], v238 offset:4096
    ds_read_b128 v[72:75], v238 offset:6144
    v_mfma_f32_16x16x32_bf16 v[48:51], a[12:15], v[80:83], v[48:51]
    s_add_u32 m0, s52, 86016
    v_mfma_f32_16x16x32_bf16 v[36:39], a[16:19], v[84:87], v[36:39]
    s_waitcnt vmcnt(12)
    v_mfma_f32_16x16x32_bf16 v[44:47], v[84:87], a[20:23], v[44:47]
    buffer_load_dwordx4 v245, s[16:19], s54 offen offset:0 lds
    v_mfma_f32_16x16x32_bf16 v[52:55], a[12:15], v[84:87], v[52:55]
    s_waitcnt lgkmcnt(2)
    s_add_u32 m0, s52, 86912
    ds_read_b64_tr_b16 a[192:193], v225 offset:0
    v_mfma_f32_16x16x32_bf16 v[32:35], a[28:31], v[56:59], v[32:35]
    ds_read_b128 v[80:83], v237 offset:8192
    ds_read_b128 v[84:87], v237 offset:10240
    v_mfma_f32_16x16x32_bf16 v[40:43], v[56:59], a[32:35], v[40:43]
    v_mfma_f32_16x16x32_bf16 v[48:51], a[24:27], v[56:59], v[48:51]
    ds_read_b64_tr_b16 a[194:195], v225 offset:2048
    v_mfma_f32_16x16x32_bf16 v[36:39], a[28:31], v[60:63], v[36:39]
    buffer_load_dwordx4 v245, s[16:19], s54 offen offset:128 lds
    v_mfma_f32_16x16x32_bf16 v[44:47], v[60:63], a[32:35], v[44:47]
    s_add_u32 m0, s52, 88064
    v_mfma_f32_16x16x32_bf16 v[52:55], a[24:27], v[60:63], v[52:55]
    s_waitcnt lgkmcnt(4)
    ds_read_b64_tr_b16 a[196:197], v225 offset:8
    v_mfma_f32_16x16x32_bf16 v[32:35], a[40:43], v[68:71], v[32:35]
    ds_read_b128 v[56:59], v238 offset:8192
    ds_read_b128 v[60:63], v238 offset:10240
    v_mfma_f32_16x16x32_bf16 v[40:43], v[68:71], a[44:47], v[40:43]
    buffer_load_dwordx4 v244, s[16:19], s54 offen offset:0 lds
    v_mfma_f32_16x16x32_bf16 v[48:51], a[36:39], v[68:71], v[48:51]
    s_add_u32 s54, s54, 88064
    s_add_u32 m0, s52, 98304
    ds_read_b64_tr_b16 a[198:199], v225 offset:2056
    v_mfma_f32_16x16x32_bf16 v[36:39], a[40:43], v[72:75], v[36:39]
    v_mfma_f32_16x16x32_bf16 v[44:47], v[72:75], a[44:47], v[44:47]
    v_mfma_f32_16x16x32_bf16 v[52:55], a[36:39], v[72:75], v[52:55]
    s_waitcnt lgkmcnt(5)
    ds_read_b64_tr_b16 a[200:201], v226 offset:0
    v_mfma_f32_16x16x32_bf16 v[32:35], a[52:55], v[80:83], v[32:35]
    buffer_load_dwordx4 v245, s[16:19], s54 offen offset:0 lds
    v_mfma_f32_16x16x32_bf16 v[40:43], v[80:83], a[56:59], v[40:43]
    ds_read_b128 v[68:71], v237 offset:12288
    ds_read_b128 v[72:75], v237 offset:14336
    v_mfma_f32_16x16x32_bf16 v[48:51], a[48:51], v[80:83], v[48:51]
    s_add_u32 m0, s52, 99200
    ds_read_b64_tr_b16 a[202:203], v226 offset:2048
    v_mfma_f32_16x16x32_bf16 v[36:39], a[52:55], v[84:87], v[36:39]
    v_mfma_f32_16x16x32_bf16 v[44:47], v[84:87], a[56:59], v[44:47]
    ds_read_b64_tr_b16 a[204:205], v226 offset:8
    v_mfma_f32_16x16x32_bf16 v[52:55], a[48:51], v[84:87], v[52:55]
    s_waitcnt lgkmcnt(6)
    v_mfma_f32_16x16x32_bf16 v[32:35], a[64:67], v[56:59], v[32:35]
    buffer_load_dwordx4 v245, s[16:19], s54 offen offset:128 lds
    v_mfma_f32_16x16x32_bf16 v[40:43], v[56:59], a[68:71], v[40:43]
    s_add_u32 m0, s52, 100352
    ds_read_b128 v[80:83], v238 offset:12288
    ds_read_b128 v[84:87], v238 offset:14336
    v_mfma_f32_16x16x32_bf16 v[48:51], a[60:63], v[56:59], v[48:51]
    ds_read_b64_tr_b16 a[206:207], v226 offset:2056
    v_mfma_f32_16x16x32_bf16 v[36:39], a[64:67], v[60:63], v[36:39]
    buffer_load_dwordx4 v244, s[16:19], s54 offen offset:0 lds
    v_mfma_f32_16x16x32_bf16 v[44:47], v[60:63], a[68:71], v[44:47]
    s_add_u32 s54, s54, 88064
    s_add_u32 m0, s52, 110592
    s_waitcnt vmcnt(14)
    v_mfma_f32_16x16x32_bf16 v[52:55], a[60:63], v[60:63], v[52:55]
    s_waitcnt lgkmcnt(5)
    v_mfma_f32_16x16x32_bf16 v[32:35], a[76:79], v[68:71], v[32:35]
    ds_read_b128 v[56:59], v237 offset:16384
    ds_read_b128 v[60:63], v237 offset:18432
    v_mfma_f32_16x16x32_bf16 v[40:43], v[68:71], a[80:83], v[40:43]
    ds_read_b64_tr_b16 a[208:209], v225 offset:16384
    v_mfma_f32_16x16x32_bf16 v[48:51], a[72:75], v[68:71], v[48:51]
    buffer_load_dwordx4 v245, s[16:19], s54 offen offset:0 lds
    v_mfma_f32_16x16x32_bf16 v[36:39], a[76:79], v[72:75], v[36:39]
    s_add_u32 m0, s52, 111488
    ds_read_b64_tr_b16 a[210:211], v225 offset:18432
    v_mfma_f32_16x16x32_bf16 v[44:47], v[72:75], a[80:83], v[44:47]
    v_mfma_f32_16x16x32_bf16 v[52:55], a[72:75], v[72:75], v[52:55]
    s_waitcnt lgkmcnt(5)
    v_mfma_f32_16x16x32_bf16 v[32:35], a[88:91], v[80:83], v[32:35]
    ds_read_b128 v[68:71], v238 offset:16384
    ds_read_b128 v[72:75], v238 offset:18432
    v_mfma_f32_16x16x32_bf16 v[40:43], v[80:83], a[92:95], v[40:43]
    buffer_load_dwordx4 v245, s[16:19], s54 offen offset:128 lds
    v_mfma_f32_16x16x32_bf16 v[48:51], a[84:87], v[80:83], v[48:51]
    s_add_u32 m0, s52, 112640
    ds_read_b64_tr_b16 a[212:213], v225 offset:16392
    v_mfma_f32_16x16x32_bf16 v[36:39], a[88:91], v[84:87], v[36:39]
    ds_read_b64_tr_b16 a[214:215], v225 offset:18440
    v_mfma_f32_16x16x32_bf16 v[44:47], v[84:87], a[92:95], v[44:47]
    s_waitcnt vmcnt(10)
    s_mov_b64 exec, 2
    s_cmp_lg_u32 s97, 0
    s_cbranch_scc1 L_XS_15
    buffer_store_dword v254, v255, s[32:35], s58 offen offset:240
L_XD_16:
    s_mov_b64 exec, -1
    v_mfma_f32_16x16x32_bf16 v[52:55], a[84:87], v[84:87], v[52:55]
    s_waitcnt lgkmcnt(6)
    v_mfma_f32_16x16x32_bf16 v[32:35], a[100:103], v[56:59], v[32:35]
    buffer_load_dwordx4 v244, s[16:19], s54 offen offset:0 lds
    v_mfma_f32_16x16x32_bf16 v[40:43], v[56:59], a[104:107], v[40:43]
    s_add_u32 s54, s54, 88064
    ds_read_b128 v[80:83], v237 offset:20480
    ds_read_b128 v[84:87], v237 offset:22528
    v_mfma_f32_16x16x32_bf16 v[48:51], a[96:99], v[56:59], v[48:51]
    s_add_u32 m0, s53, 0
    ds_read_b64_tr_b16 a[216:217], v226 offset:16384
    v_mfma_f32_16x16x32_bf16 v[36:39], a[100:103], v[60:63], v[36:39]
    ds_read_b64_tr_b16 a[218:219], v226 offset:18432
    v_mfma_f32_16x16x32_bf16 v[44:47], v[60:63], a[104:107], v[44:47]
    v_mfma_f32_16x16x32_bf16 v[52:55], a[96:99], v[60:63], v[52:55]
    s_waitcnt lgkmcnt(6)
    v_mfma_f32_16x16x32_bf16 v[32:35], a[112:115], v[68:71], v[32:35]
    buffer_load_dwordx4 v250, s[12:15], s51 offen offset:0 lds
    v_mfma_f32_16x16x32_bf16 v[40:43], v[68:71], a[116:119], v[40:43]
    ds_read_b128 v[56:59], v238 offset:20480
    ds_read_b128 v[60:63], v238 offset:22528
    v_mfma_f32_16x16x32_bf16 v[48:51], a[108:111], v[68:71], v[48:51]
    ds_read_b64_tr_b16 a[220:221], v226 offset:16392
    ds_read_b64_tr_b16 a[222:223], v226 offset:18440
    v_mfma_f32_16x16x32_bf16 v[36:39], a[112:115], v[72:75], v[36:39]
    buffer_load_dwordx4 v251, s[12:15], s51 offen offset:1024 lds
    v_mfma_f32_16x16x32_bf16 v[44:47], v[72:75], a[116:119], v[44:47]
    v_mfma_f32_16x16x32_bf16 v[52:55], a[108:111], v[72:75], v[52:55]
    s_waitcnt lgkmcnt(6)
    v_mfma_f32_16x16x32_bf16 v[32:35], a[124:127], v[80:83], v[32:35]
    buffer_load_dwordx4 v252, s[12:15], s51 offen offset:2048 lds
    v_mfma_f32_16x16x32_bf16 v[40:43], v[80:83], a[128:131], v[40:43]
    ds_read_b128 v[68:71], v237 offset:24576
    ds_read_b128 v[72:75], v237 offset:26624
    v_mfma_f32_16x16x32_bf16 v[48:51], a[120:123], v[80:83], v[48:51]
    ds_read_b64_tr_b16 a[224:225], v225 offset:32768
    v_mfma_f32_16x16x32_bf16 v[36:39], a[124:127], v[84:87], v[36:39]
    buffer_load_dwordx4 v253, s[12:15], s51 offen offset:3072 lds
    v_mfma_f32_16x16x32_bf16 v[44:47], v[84:87], a[128:131], v[44:47]
    s_add_u32 s51, s51, 32768
    s_add_u32 m0, s52, 49152
    v_mfma_f32_16x16x32_bf16 v[52:55], a[120:123], v[84:87], v[52:55]
    s_waitcnt lgkmcnt(5)
    ds_read_b64_tr_b16 a[226:227], v225 offset:34816
    v_mfma_f32_16x16x32_bf16 v[32:35], a[136:139], v[56:59], v[32:35]
    ds_read_b128 v[80:83], v238 offset:24576
    ds_read_b128 v[84:87], v238 offset:26624
    v_mfma_f32_16x16x32_bf16 v[40:43], v[56:59], a[140:143], v[40:43]
    v_mfma_f32_16x16x32_bf16 v[48:51], a[132:135], v[56:59], v[48:51]
    buffer_load_dword v239, v228, s[32:35], s59 offen offset:256 sc1
    v_mfma_f32_16x16x32_bf16 v[36:39], a[136:139], v[60:63], v[36:39]
    buffer_load_dwordx4 v245, s[16:19], s54 offen offset:0 lds
    v_mfma_f32_16x16x32_bf16 v[44:47], v[60:63], a[140:143], v[44:47]
    s_add_u32 m0, s52, 50048
    ds_read_b64_tr_b16 a[228:229], v225 offset:32776
    ds_read_b64_tr_b16 a[230:231], v225 offset:34824
    v_mfma_f32_16x16x32_bf16 v[52:55], a[132:135], v[60:63], v[52:55]
    s_waitcnt lgkmcnt(6)
    v_mfma_f32_16x16x32_bf16 v[32:35], a[148:151], v[68:71], v[32:35]
    ds_read_b128 v[56:59], v237 offset:28672
    ds_read_b128 v[60:63], v237 offset:30720
    v_mfma_f32_16x16x32_bf16 v[40:43], v[68:71], a[152:155], v[40:43]
    buffer_load_dwordx4 v245, s[16:19], s54 offen offset:128 lds
    v_mfma_f32_16x16x32_bf16 v[48:51], a[144:147], v[68:71], v[48:51]
    s_add_u32 m0, s52, 51200
    ds_read_b64_tr_b16 a[232:233], v226 offset:32768
    v_mfma_f32_16x16x32_bf16 v[36:39], a[148:151], v[72:75], v[36:39]
    s_branch L_O2
.p2alignl 12, 0xbf810000
L_HN02:
    s_branch L_BN0
L_HU02:
    s_branch L_BU0
L_HL02:
    s_branch L_BL0
L_O2:
    v_mfma_f32_16x16x32_bf16 v[44:47], v[72:75], a[152:155], v[44:47]
    ds_read_b64_tr_b16 a[234:235], v226 offset:34816
    v_mfma_f32_16x16x32_bf16 v[52:55], a[144:147], v[72:75], v[52:55]
    s_waitcnt lgkmcnt(6)
    v_mfma_f32_16x16x32_bf16 v[32:35], a[160:163], v[80:83], v[32:35]
    buffer_load_dwordx4 v244, s[16:19], s54 offen offset:0 lds
    buffer_load_dword v240, v228, s[32:35], s59 offen offset:256 sc1
    v_mfma_f32_16x16x32_bf16 v[40:43], v[80:83], a[164:167], v[40:43]
    s_add_u32 s54, s54, 88064
    ds_read_b128 v[68:71], v238 offset:28672
    ds_read_b128 v[72:75], v238 offset:30720
    v_mfma_f32_16x16x32_bf16 v[48:51], a[156:159], v[80:83], v[48:51]
    s_add_u32 m0, s52, 61440
    ds_read_b64_tr_b16 a[236:237], v226 offset:32776
    v_mfma_f32_16x16x32_bf16 v[36:39], a[160:163], v[84:87], v[36:39]
    v_mfma_f32_16x16x32_bf16 v[44:47], v[84:87], a[164:167], v[44:47]
    ds_read_b64_tr_b16 a[238:239], v226 offset:34824
    v_mfma_f32_16x16x32_bf16 v[52:55], a[156:159], v[84:87], v[52:55]
    s_waitcnt lgkmcnt(6)
    v_mfma_f32_16x16x32_bf16 v[32:35], a[172:175], v[56:59], v[32:35]
    buffer_load_dwordx4 v245, s[16:19], s54 offen offset:0 lds
    v_mfma_f32_16x16x32_bf16 v[40:43], v[56:59], a[176:179], v[40:43]
    s_add_u32 m0, s52, 62336
    v_mfma_f32_16x16x32_bf16 v[48:51], a[168:171], v[56:59], v[48:51]
    v_mfma_f32_16x16x32_bf16 v[36:39], a[172:175], v[60:63], v[36:39]
    buffer_load_dwordx4 v245, s[16:19], s54 offen offset:128 lds
    v_mfma_f32_16x16x32_bf16 v[44:47], v[60:63], a[176:179], v[44:47]
    buffer_load_dword v246, v228, s[32:35], s59 offen offset:256 sc1
    v_mfma_f32_16x16x32_bf16 v[52:55], a[168:171], v[60:63], v[52:55]
    s_waitcnt lgkmcnt(2)
    s_add_u32 m0, s52, 63488
    v_mfma_f32_16x16x32_bf16 v[32:35], a[184:187], v[68:71], v[32:35]
    v_mfma_f32_16x16x32_bf16 v[40:43], v[68:71], a[188:191], v[40:43]
    buffer_load_dwordx4 v244, s[16:19], s54 offen offset:0 lds
    v_mfma_f32_16x16x32_bf16 v[48:51], a[180:183], v[68:71], v[48:51]
    s_add_u32 s54, s54, 88064
    v_mfma_f32_16x16x32_bf16 v[36:39], a[184:187], v[72:75], v[36:39]
    v_mfma_f32_16x16x32_bf16 v[44:47], v[72:75], a[188:191], v[44:47]
    v_mfma_f32_16x16x32_bf16 v[52:55], a[180:183], v[72:75], v[52:55]
    s_waitcnt vmcnt(13) lgkmcnt(0)
    s_barrier
    v_cvt_pk_bf16_f32 v110, v32, v33
    s_add_u32 m0, s52, 24576
    s_nop 0
    buffer_load_dwordx4 v245, s[16:19], s54 offen offset:0 lds
    v_cvt_pk_bf16_f32 v111, v34, v35
    v_cvt_pk_bf16_f32 v124, v48, v49
    v_cvt_pk_bf16_f32 v125, v50, v51
    v_cvt_pk_bf16_f32 v112, v36, v37
    v_cvt_pk_bf16_f32 v113, v38, v39
    v_cvt_pk_bf16_f32 v126, v52, v53
    s_add_u32 m0, s52, 25472
    s_nop 0
    buffer_load_dwordx4 v245, s[16:19], s54 offen offset:128 lds
    v_cvt_pk_bf16_f32 v127, v54, v55
    v_mfma_f32_16x16x16_bf16 v[128:131], v[106:107], v[124:125], v[170:173]
    v_mfma_f32_16x16x16_bf16 v[136:139], v[110:111], v[124:125], v[166:169]
    v_mfma_f32_16x16x16_bf16 v[132:135], v[108:109], v[126:127], v[170:173]
    v_mfma_f32_16x16x16_bf16 v[140:143], v[112:113], v[126:127], v[166:169]
    v_cvt_pk_bf16_f32 v122, v40, v41
    v_cvt_pk_bf16_f32 v123, v42, v43
    s_add_u32 m0, s52, 26624
    s_nop 0
    buffer_load_dwordx4 v244, s[16:19], s54 offen offset:0 lds
    s_add_u32 s54, s54, 88064
    v_cvt_pk_bf16_f32 v114, v44, v45
    v_cvt_pk_bf16_f32 v115, v46, v47
    v_add_u32 v220, 73728, v229
    v_add_u32 v221, 73728, v230
    v_add_u32 v222, 73728, v231
    ds_read_b64_tr_b16 a[0:1], v220 offset:0
    ds_read_b64_tr_b16 a[2:3], v220 offset:6144
    s_waitcnt vmcnt(11)
    v_cmp_ne_u32 vcc, s96, v239
    s_nop 1
    s_cbranch_vccz L_WD_17
    s_waitcnt vmcnt(7)
    v_cmp_ne_u32 vcc, s96, v240
    s_nop 3
    s_cbranch_vccz L_WD_17
    s_waitcnt vmcnt(4)
    v_cmp_ne_u32 vcc, s96, v246
    s_nop 3
    s_cbranch_vccz L_WD_17
    s_mov_b32 s40, 20000
L_WF_19:
    v_xor_b32 v239, s96, v239
    v_cmp_lt_u32 vcc, 15, v239
    s_nop 3
    s_cbranch_vccz L_WK_20
    buffer_load_dword v239, v228, s[32:35], s59 offen offset:256 sc1
    s_waitcnt vmcnt(0)
    s_sub_u32 s40, s40, 1
    s_cbranch_scc0 L_WF_19
L_WK_20:
L_WD_17:
    ds_read_b64_tr_b16 a[4:5], v221 offset:0
    v_max_f32 v128, v128, v136
    v_max_f32 v129, v129, v137
    v_max_f32 v130, v130, v138
    v_max_f32 v131, v131, v139
    v_max3_f32 v144, v128, v129, v130
    buffer_load_dwordx4 v[0:3], v255, s[32:35], s72 offen offset:0 sc1
    v_max_f32 v144, v144, v131
    v_max_f32 v132, v132, v140
    v_max_f32 v133, v133, v141
    v_max_f32 v134, v134, v142
    v_max_f32 v135, v135, v143
    v_max3_f32 v145, v132, v133, v134
    buffer_load_dwordx4 v[4:7], v255, s[32:35], s72 offen offset:1024 sc1
    v_max_f32 v145, v145, v135
    ds_read_b64_tr_b16 a[6:7], v221 offset:6144
    ds_read_b64_tr_b16 a[8:9], v222 offset:0
    ds_read_b64_tr_b16 a[10:11], v222 offset:6144
    ds_read_b64_tr_b16 a[12:13], v220 offset:12288
    ds_read_b64_tr_b16 a[14:15], v220 offset:18432
    buffer_load_dwordx4 v[8:11], v255, s[32:35], s72 offen offset:2048 sc1
    ds_read_b64_tr_b16 a[16:17], v221 offset:12288
    v_permlane32_swap_b32 v144, v145
    v_max_f32 v144, v144, v145
    v_mov_b32 v145, v144
    ds_read_b64_tr_b16 a[18:19], v221 offset:18432
    ds_read_b64_tr_b16 a[20:21], v222 offset:12288
    buffer_load_dwordx4 v[12:15], v255, s[32:35], s72 offen offset:3072 sc1
    ds_read_b64_tr_b16 a[22:23], v222 offset:18432
    ds_read_b64_tr_b16 a[24:25], v220 offset:24576
    ds_read_b64_tr_b16 a[26:27], v220 offset:30720
    ds_read_b64_tr_b16 a[28:29], v221 offset:24576
    v_permlane16_swap_b32 v144, v145
    v_max_f32 v144, v144, v145
    v_mul_f32 v146, 0xbeb8aa3b, v144
    buffer_load_dwordx4 v[16:19], v255, s[32:35], s73 offen offset:0 sc1
    v_mul_f32 v144, 0xbeb8aa3b, v144
    ds_read_b64_tr_b16 a[30:31], v221 offset:30720
    ds_read_b64_tr_b16 a[32:33], v222 offset:24576
    ds_read_b64_tr_b16 a[34:35], v222 offset:30720
    ds_read_b64_tr_b16 a[36:37], v220 offset:36864
    ds_read_b64_tr_b16 a[38:39], v220 offset:43008
    buffer_load_dwordx4 v[20:23], v255, s[32:35], s73 offen offset:1024 sc1
    ds_read_b64_tr_b16 a[40:41], v221 offset:36864
    v_permlane32_swap_b32 v144, v146
    v_pk_fma_f32 v[128:129], v[128:129], s[44:45], v[144:145] op_sel_hi:[1,1,0]
    v_pk_fma_f32 v[130:131], v[130:131], s[44:45], v[144:145] op_sel_hi:[1,1,0]
    v_pk_fma_f32 v[132:133], v[132:133], s[44:45], v[146:147] op_sel_hi:[1,1,0]
    v_pk_fma_f32 v[134:135], v[134:135], s[44:45], v[146:147] op_sel_hi:[1,1,0]
    buffer_load_dwordx4 v[24:27], v255, s[32:35], s73 offen offset:2048 sc1
    v_exp_f32 v128, v128
    v_exp_f32 v129, v129
    v_exp_f32 v130, v130
    v_exp_f32 v131, v131
    v_cvt_pk_bf16_f32 v156, v128, v129
    v_cvt_pk_bf16_f32 v157, v130, v131
    buffer_load_dwordx4 v[28:31], v255, s[32:35], s73 offen offset:3072 sc1
    v_bfi_b32 v148, v182, 0, v156
    v_and_b32 v150, v182, v156
    v_bfi_b32 v149, v183, 0, v157
    v_and_b32 v151, v183, v157
    v_exp_f32 v132, v132
    v_exp_f32 v133, v133
    v_exp_f32 v134, v134
    v_exp_f32 v135, v135
    v_mfma_f32_16x16x16_bf16 v[136:139], v[184:185], v[156:157], 0
    v_mfma_f32_16x16x32_bf16 v[128:131], v[120:123], v[148:151], 0
    v_cvt_pk_bf16_f32 v158, v132, v133
    v_cvt_pk_bf16_f32 v159, v134, v135
    v_bfi_b32 v154, v182, 0, v158
    v_and_b32 v152, v182, v158
    v_bfi_b32 v155, v183, 0, v159
    v_and_b32 v153, v183, v159
    s_nop 0
    v_rcp_f32 v136, v136
    v_mfma_f32_16x16x16_bf16 v[140:143], v[184:185], v[158:159], 0
    v_mfma_f32_16x16x32_bf16 v[132:135], v[114:117], v[152:155], 0
    v_pk_mul_f32 v[128:129], v[128:129], v[136:137] op_sel_hi:[1,0]
    v_pk_mul_f32 v[130:131], v[130:131], v[136:137] op_sel_hi:[1,0]
    v_cvt_pk_bf16_f32 v124, v128, v129
    v_cvt_pk_bf16_f32 v125, v130, v131
    ds_read_b64_tr_b16 a[42:43], v221 offset:43008
    ds_read_b64_tr_b16 a[44:45], v222 offset:36864
    ds_read_b64_tr_b16 a[46:47], v222 offset:43008
    ds_read_b64_tr_b16 a[240:241], v225 offset:0
    ds_read_b64_tr_b16 a[242:243], v225 offset:2048
    v_rcp_f32 v140, v140
    s_nop 0
    v_pk_mul_f32 v[132:133], v[132:133], v[140:141] op_sel_hi:[1,0]
    v_pk_mul_f32 v[134:135], v[134:135], v[140:141] op_sel_hi:[1,0]
    v_cvt_pk_bf16_f32 v126, v132, v133
    v_cvt_pk_bf16_f32 v127, v134, v135
    ds_read_b64_tr_b16 a[244:245], v225 offset:8
    ds_read_b64_tr_b16 a[246:247], v225 offset:2056
    ds_read_b64_tr_b16 a[248:249], v226 offset:0
    ds_read_b64_tr_b16 a[250:251], v226 offset:2048
    ds_read_b64_tr_b16 a[252:253], v226 offset:8
    ds_read_b64_tr_b16 a[254:255], v226 offset:2056
    v_permlane16_swap_b32 v124, v126
    v_permlane16_swap_b32 v125, v127
    buffer_store_dwordx4 v[124:127], v233, s[32:35], s80 offen sc1
    ds_write_b64 v160, v[92:93]
    ds_write_b64 v160, v[96:97] offset:2048
    s_waitcnt vmcnt(9) lgkmcnt(0)
    s_barrier
    s_waitcnt vmcnt(8)
    v_mfma_f32_16x16x32_bf16 v[64:67], a[192:195], v[0:3], 0
    ds_read_b128 v[136:139], v219 offset:0
    ds_read_b128 v[140:143], v219 offset:2048
    v_mfma_f32_16x16x32_bf16 v[68:71], a[196:199], v[0:3], 0
    ds_read_b128 v[202:205], v219 offset:3072
    v_lshlrev_b32 v120, 16, v206
    s_waitcnt vmcnt(7)
    v_mfma_f32_16x16x32_bf16 v[64:67], a[208:211], v[4:7], v[64:67]
    v_and_b32 v121, 0xffff0000, v206
    v_lshlrev_b32 v122, 16, v207
    v_mfma_f32_16x16x32_bf16 v[68:71], a[212:215], v[4:7], v[68:71]
    v_and_b32 v123, 0xffff0000, v207
    v_lshlrev_b32 v124, 16, v208
    s_waitcnt vmcnt(6)
    v_mfma_f32_16x16x32_bf16 v[64:67], a[224:227], v[8:11], v[64:67]
    s_add_u32 m0, s52, 36864
    v_and_b32 v125, 0xffff0000, v208
    v_lshlrev_b32 v126, 16, v209
    v_mfma_f32_16x16x32_bf16 v[68:71], a[228:231], v[8:11], v[68:71]
    buffer_load_dwordx4 v245, s[16:19], s54 offen offset:0 lds
    s_waitcnt vmcnt(6)
    v_mfma_f32_16x16x32_bf16 v[64:67], a[240:243], v[12:15], v[64:67]
    s_add_u32 m0, s52, 37760
    v_and_b32 v127, 0xffff0000, v209
    v_mov_b32 v128, 0
    v_mfma_f32_16x16x32_bf16 v[68:71], a[244:247], v[12:15], v[68:71]
    buffer_load_dwordx4 v245, s[16:19], s54 offen offset:128 lds
    v_mfma_f32_16x16x32_bf16 v[72:75], a[200:203], v[0:3], 0
    s_add_u32 m0, s52, 38912
    v_mov_b32 v129, 0
    v_and_b32 v222, 8, v242
    v_mfma_f32_16x16x32_bf16 v[76:79], a[204:207], v[0:3], 0
    ds_write_b128 v214, v[64:67] offset:32768
    v_mfma_f32_16x16x32_bf16 v[72:75], a[216:219], v[4:7], v[72:75]
    buffer_load_dwordx4 v244, s[16:19], s54 offen offset:0 lds
    v_mfma_f32_16x16x32_bf16 v[76:79], a[220:223], v[4:7], v[76:79]
    ds_write_b128 v214, v[68:71] offset:33792
    v_mfma_f32_16x16x32_bf16 v[72:75], a[232:235], v[8:11], v[72:75]
    s_add_u32 s54, s54, 88064
    v_lshlrev_b32 v222, 7, v222
    v_sub_u32 v222, 157696, v222
    v_mfma_f32_16x16x32_bf16 v[76:79], a[236:239], v[8:11], v[76:79]
    s_add_u32 m0, s52, 86016
    v_lshl_add_u32 v219, v243, 4, v222
    s_waitcnt lgkmcnt(4)
    v_lshlrev_b32 v186, 16, v136
    v_mfma_f32_16x16x32_bf16 v[72:75], a[248:251], v[12:15], v[72:75]
    buffer_load_dwordx4 v245, s[16:19], s54 offen offset:0 lds
    v_mfma_f32_16x16x32_bf16 v[76:79], a[252:255], v[12:15], v[76:79]
    s_add_u32 m0, s52, 86912
    v_and_b32 v187, 0xffff0000, v136
    v_lshlrev_b32 v188, 16, v137
    s_waitcnt vmcnt(8)
    v_mfma_f32_16x16x32_bf16 v[80:83], a[192:195], v[16:19], 0
    buffer_load_dwordx4 v245, s[16:19], s54 offen offset:128 lds
    v_mfma_f32_16x16x32_bf16 v[84:87], a[196:199], v[16:19], 0
    ds_write_b128 v215, v[72:75] offset:34816
    s_waitcnt vmcnt(8)
    v_mfma_f32_16x16x32_bf16 v[80:83], a[208:211], v[20:23], v[80:83]
    ds_write_b128 v215, v[76:79] offset:35840
    v_mfma_f32_16x16x32_bf16 v[84:87], a[212:215], v[20:23], v[84:87]
    s_add_u32 m0, s52, 88064
    v_and_b32 v189, 0xffff0000, v137
    v_lshlrev_b32 v190, 16, v138
    s_waitcnt vmcnt(7)
    v_mfma_f32_16x16x32_bf16 v[80:83], a[224:227], v[24:27], v[80:83]
    buffer_load_dwordx4 v244, s[16:19], s54 offen offset:0 lds
    v_mfma_f32_16x16x32_bf16 v[84:87], a[228:231], v[24:27], v[84:87]
    s_add_u32 s54, s54, 88064
    v_and_b32 v191, 0xffff0000, v138
    v_lshlrev_b32 v192, 16, v139
    s_waitcnt vmcnt(7)
    v_mfma_f32_16x16x32_bf16 v[80:83], a[240:243], v[28:31], v[80:83]
    s_add_u32 m0, s52, 98304
    v_and_b32 v193, 0xffff0000, v139
    s_waitcnt lgkmcnt(5)
    v_lshlrev_b32 v194, 16, v140
    v_mfma_f32_16x16x32_bf16 v[84:87], a[244:247], v[28:31], v[84:87]
    buffer_load_dwordx4 v245, s[16:19], s54 offen offset:0 lds
    v_mfma_f32_16x16x32_bf16 v[88:91], a[200:203], v[16:19], 0
    s_add_u32 m0, s52, 99200
    v_and_b32 v195, 0xffff0000, v140
    v_lshlrev_b32 v196, 16, v141
    v_mfma_f32_16x16x32_bf16 v[92:95], a[204:207], v[16:19], 0
    ds_write_b128 v216, v[80:83] offset:36864
    v_mfma_f32_16x16x32_bf16 v[88:91], a[216:219], v[20:23], v[88:91]
    buffer_load_dwordx4 v245, s[16:19], s54 offen offset:128 lds
    v_mfma_f32_16x16x32_bf16 v[92:95], a[220:223], v[20:23], v[92:95]
    ds_write_b128 v216, v[84:87] offset:37888
    v_and_b32 v197, 0xffff0000, v141
    v_mfma_f32_16x16x32_bf16 v[88:91], a[232:235], v[24:27], v[88:91]
    s_add_u32 m0, s52, 100352
    v_lshlrev_b32 v198, 16, v142
    v_and_b32 v199, 0xffff0000, v142
    v_mfma_f32_16x16x32_bf16 v[92:95], a[236:239], v[24:27], v[92:95]
    buffer_load_dwordx4 v244, s[16:19], s54 offen offset:0 lds
    v_lshlrev_b32 v200, 16, v143
    v_and_b32 v201, 0xffff0000, v143
    ds_read_b128 v[32:35], v219 offset:0
    ds_read_b128 v[36:39], v219 offset:64
    v_mfma_f32_16x16x32_bf16 v[88:91], a[248:251], v[28:31], v[88:91]
    s_waitcnt vmcnt(9)
    s_mov_b64 exec, 2
    s_cmp_lg_u32 s97, 0
    s_cbranch_scc1 L_XS_21
    buffer_store_dword v254, v255, s[32:35], s58 offen offset:368
L_XD_22:
    s_mov_b64 exec, -1
    v_mfma_f32_16x16x32_bf16 v[92:95], a[252:255], v[28:31], v[92:95]
    s_add_u32 s54, s54, 88064
    s_waitcnt lgkmcnt(0)
    s_barrier
    ds_read_b128 v[96:99], v217 offset:32768
    ds_read_b128 v[100:103], v217 offset:33792
    ds_read_b128 v[104:107], v217 offset:34816
    ds_read_b128 v[108:111], v217 offset:35840
    ds_read_b128 v[112:115], v217 offset:36864
    ds_read_b128 v[116:119], v217 offset:37888
    v_mfma_f32_16x16x32_bf16 v[162:165], a[0:3], v[32:35], 0
    v_mfma_f32_16x16x32_bf16 v[166:169], a[4:7], v[32:35], 0
    v_mfma_f32_16x16x32_bf16 v[170:173], a[8:11], v[32:35], 0
    v_mfma_f32_16x16x32_bf16 v[162:165], a[12:15], v[36:39], v[162:165]
    v_mfma_f32_16x16x32_bf16 v[166:169], a[16:19], v[36:39], v[166:169]
    v_mfma_f32_16x16x32_bf16 v[170:173], a[20:23], v[36:39], v[170:173]
    s_waitcnt lgkmcnt(3)
    v_pk_add_f32 v[96:97], v[96:97], v[104:105]
    s_add_u32 m0, s52, 110592
    s_nop 0
    buffer_load_dwordx4 v245, s[16:19], s54 offen offset:0 lds
    v_pk_add_f32 v[98:99], v[98:99], v[106:107]
    s_waitcnt lgkmcnt(2)
    v_pk_add_f32 v[100:101], v[100:101], v[108:109]
    v_pk_add_f32 v[102:103], v[102:103], v[110:111]
    s_waitcnt lgkmcnt(1)
    v_pk_add_f32 v[88:89], v[88:89], v[112:113]
    v_pk_add_f32 v[90:91], v[90:91], v[114:115]
    s_waitcnt lgkmcnt(0)
    v_pk_add_f32 v[92:93], v[92:93], v[116:117]
    s_add_u32 m0, s52, 111488
    s_nop 0
    buffer_load_dwordx4 v245, s[16:19], s54 offen offset:128 lds
    v_pk_add_f32 v[94:95], v[94:95], v[118:119]
    v_pk_add_f32 v[88:89], v[88:89], v[96:97]
    v_pk_add_f32 v[90:91], v[90:91], v[98:99]
    v_pk_add_f32 v[92:93], v[92:93], v[100:101]
    v_pk_add_f32 v[94:95], v[94:95], v[102:103]
    v_pk_fma_f32 v[88:89], v[88:89], v[186:187], v[120:121]
    s_add_u32 m0, s52, 112640
    s_nop 0
    buffer_load_dwordx4 v244, s[16:19], s54 offen offset:0 lds
    s_add_u32 s54, s54, 88064
    v_pk_fma_f32 v[90:91], v[90:91], v[188:189], v[122:123]
    v_pk_fma_f32 v[92:93], v[92:93], v[190:191], v[124:125]
    v_pk_fma_f32 v[94:95], v[94:95], v[192:193], v[126:127]
    v_pk_mul_f32 v[120:121], v[88:89], v[194:195]
    v_pk_mul_f32 v[122:123], v[90:91], v[196:197]
    v_pk_mul_f32 v[124:125], v[92:93], v[198:199]
    s_add_u32 m0, s52, 73728
    s_nop 0
    buffer_load_dwordx4 v245, s[16:19], s54 offen offset:0 lds
    v_pk_mul_f32 v[126:127], v[94:95], v[200:201]
    v_cvt_pk_bf16_f32 v96, v120, v121
    v_cvt_pk_bf16_f32 v97, v122, v123
    v_cvt_pk_bf16_f32 v98, v124, v125
    v_cvt_pk_bf16_f32 v99, v126, v127
    buffer_store_dwordx4 v[96:99], v255, s[32:35], s81 offen sc1
    buffer_load_dword v239, v228, s[32:35], s59 offen offset:384 sc1
    v_cvt_pk_bf16_f32 v206, v88, v89
    v_cvt_pk_bf16_f32 v207, v90, v91
    v_cvt_pk_bf16_f32 v208, v92, v93
    v_cvt_pk_bf16_f32 v209, v94, v95
    v_dot2c_f32_bf16 v128, s41, v206
    v_dot2c_f32_bf16 v129, v206, v206
    v_dot2c_f32_bf16 v128, s41, v207
    v_dot2c_f32_bf16 v129, v207, v207
    v_dot2c_f32_bf16 v128, s41, v208
    v_dot2c_f32_bf16 v129, v208, v208
    v_dot2c_f32_bf16 v128, s41, v209
    v_dot2c_f32_bf16 v129, v209, v209
    ds_read_b128 v[0:3], v219 offset:128
    ds_read_b128 v[4:7], v219 offset:192
    s_nop 0
    v_permlane32_swap_b32 v128, v129
    v_add_f32 v128, v128, v129
    buffer_load_dword v240, v228, s[32:35], s59 offen offset:384 sc1
    v_mov_b32 v129, v128
    ds_read_b128 v[8:11], v219 offset:256
    ds_read_b128 v[12:15], v219 offset:320
    v_permlane16_swap_b32 v128, v129
    v_add_f32 v128, v128, v129
    buffer_store_dword v128, v218, s[32:35], s98 offen sc1
    s_add_u32 s81, s81, 32768
    s_add_u32 s98, s98, 4096
    s_waitcnt lgkmcnt(3)
    v_mfma_f32_16x16x32_bf16 v[162:165], a[24:27], v[0:3], v[162:165]
    s_add_u32 m0, s52, 74624
    ds_read_b64_tr_b16 a[48:49], v229 offset:49152
    ds_read_b64_tr_b16 a[50:51], v229 offset:55296
    v_mfma_f32_16x16x32_bf16 v[166:169], a[28:31], v[0:3], v[166:169]
    buffer_load_dwordx4 v245, s[16:19], s54 offen offset:128 lds
    v_mfma_f32_16x16x32_bf16 v[170:173], a[32:35], v[0:3], v[170:173]
    s_add_u32 m0, s52, 75776
    ds_read_b64_tr_b16 a[52:53], v230 offset:49152
    ds_read_b64_tr_b16 a[54:55], v230 offset:55296
    s_waitcnt lgkmcnt(6)
    v_mfma_f32_16x16x32_bf16 v[162:165], a[36:39], v[4:7], v[162:165]
    buffer_load_dwordx4 v244, s[16:19], s54 offen offset:0 lds
    v_mfma_f32_16x16x32_bf16 v[166:169], a[40:43], v[4:7], v[166:169]
    s_add_u32 s54, s54, 88064
    ds_read_b64_tr_b16 a[56:57], v231 offset:49152
    ds_read_b64_tr_b16 a[58:59], v231 offset:55296
    v_add_u32 v220, 61440, v229
    v_add_u32 v221, 61440, v230
    v_add_u32 v222, 61440, v231
    ds_read_b64_tr_b16 a[60:61], v220 offset:0
    ds_read_b64_tr_b16 a[62:63], v220 offset:6144
    ds_read_b64_tr_b16 a[64:65], v221 offset:0
    ds_read_b64_tr_b16 a[66:67], v221 offset:6144
    ds_read_b64_tr_b16 a[68:69], v222 offset:0
    ds_read_b64_tr_b16 a[70:71], v222 offset:6144
    ds_read_b64_tr_b16 a[72:73], v229 offset:24576
    ds_read_b64_tr_b16 a[74:75], v229 offset:30720
    ds_read_b64_tr_b16 a[76:77], v230 offset:24576
    ds_read_b64_tr_b16 a[78:79], v230 offset:30720
    ds_read_b64_tr_b16 a[80:81], v231 offset:24576
    ds_read_b64_tr_b16 a[82:83], v231 offset:30720
    ds_read_b128 v[16:19], v219 offset:384
    v_mfma_f32_16x16x32_bf16 v[170:173], a[44:47], v[4:7], v[170:173]
    s_add_u32 m0, s52, 0
    v_lshlrev_b32 v120, 16, v210
    v_and_b32 v121, 0xffff0000, v210
    s_waitcnt lgkmcnt(15)
    v_mfma_f32_16x16x32_bf16 v[162:165], a[48:51], v[8:11], v[162:165]
    buffer_load_dwordx4 v245, s[16:19], s54 offen offset:0 lds
    s_waitcnt lgkmcnt(15)
    v_mfma_f32_16x16x32_bf16 v[166:169], a[52:55], v[8:11], v[166:169]
    s_add_u32 m0, s52, 896
    v_lshlrev_b32 v122, 16, v211
    v_and_b32 v123, 0xffff0000, v211
    s_waitcnt lgkmcnt(13)
    v_mfma_f32_16x16x32_bf16 v[170:173], a[56:59], v[8:11], v[170:173]
    v_lshlrev_b32 v124, 16, v212
    v_and_b32 v125, 0xffff0000, v212
    s_waitcnt lgkmcnt(11)
    v_mfma_f32_16x16x32_bf16 v[162:165], a[60:63], v[12:15], v[162:165]
    buffer_load_dwordx4 v245, s[16:19], s54 offen offset:128 lds
    s_waitcnt lgkmcnt(9)
    v_mfma_f32_16x16x32_bf16 v[166:169], a[64:67], v[12:15], v[166:169]
    s_add_u32 m0, s52, 2048
    v_lshlrev_b32 v126, 16, v213
    v_and_b32 v127, 0xffff0000, v213
    s_waitcnt lgkmcnt(7)
    v_mfma_f32_16x16x32_bf16 v[170:173], a[68:71], v[12:15], v[170:173]
    v_mov_b32 v128, 0
    v_mov_b32 v129, 0
    s_waitcnt lgkmcnt(0)
    v_mfma_f32_16x16x32_bf16 v[162:165], a[72:75], v[16:19], v[162:165]
    buffer_load_dwordx4 v244, s[16:19], s54 offen offset:0 lds
    v_mfma_f32_16x16x32_bf16 v[166:169], a[76:79], v[16:19], v[166:169]
    s_add_u32 s54, s54, 88064
    v_mfma_f32_16x16x32_bf16 v[170:173], a[80:83], v[16:19], v[170:173]
    s_waitcnt vmcnt(7)
    v_cmp_ne_u32 vcc, s96, v239
    s_nop 1
    s_cbranch_vccz L_WD_23
    s_waitcnt vmcnt(6)
    v_cmp_ne_u32 vcc, s96, v240
    s_nop 3
    s_cbranch_vccz L_WD_23
    s_mov_b32 s40, 20000
L_WF_25:
    v_xor_b32 v239, s96, v239
    v_cmp_lt_u32 vcc, 15, v239
    s_nop 3
    s_cbranch_vccz L_WK_26
    buffer_load_dword v239, v228, s[32:35], s59 offen offset:384 sc1
    s_waitcnt vmcnt(0)
    s_sub_u32 s40, s40, 1
    s_cbranch_scc0 L_WF_25
L_WK_26:
L_WD_23:
    buffer_load_dwordx4 v[32:35], v255, s[32:35], s74 offen offset:0 sc1
    buffer_load_dwordx4 v[36:39], v255, s[32:35], s74 offen offset:1024 sc1
    s_barrier
    ds_read_b64_tr_b16 a[84:85], v229 offset:36864
    buffer_load_dwordx4 v[40:43], v255, s[32:35], s74 offen offset:2048 sc1
    ds_read_b64_tr_b16 a[86:87], v229 offset:43008
    ds_read_b64_tr_b16 a[88:89], v230 offset:36864
    ds_read_b64_tr_b16 a[90:91], v230 offset:43008
    ds_read_b64_tr_b16 a[92:93], v231 offset:36864
    buffer_load_dwordx4 v[44:47], v255, s[32:35], s74 offen offset:3072 sc1
    ds_read_b64_tr_b16 a[94:95], v231 offset:43008
    v_add_u32 v220, 86016, v229
    v_add_u32 v221, 86016, v230
    v_add_u32 v222, 86016, v231
    buffer_load_dwordx4 v[48:51], v255, s[32:35], s75 offen offset:0 sc1
    ds_read_b128 v[0:3], v219 offset:448
    ds_read_b128 v[4:7], v219 offset:512
    ds_read_b128 v[8:11], v219 offset:576
    s_waitcnt lgkmcnt(2)
    v_mfma_f32_16x16x32_bf16 v[162:165], a[84:87], v[0:3], v[162:165]
    buffer_load_dwordx4 v[52:55], v255, s[32:35], s75 offen offset:1024 sc1
    v_mfma_f32_16x16x32_bf16 v[166:169], a[88:91], v[0:3], v[166:169]
    ds_read_b64_tr_b16 a[96:97], v220 offset:0
    ds_read_b64_tr_b16 a[98:99], v220 offset:6144
    v_mfma_f32_16x16x32_bf16 v[170:173], a[92:95], v[0:3], v[170:173]
    buffer_load_dwordx4 v[56:59], v255, s[32:35], s75 offen offset:2048 sc1
    s_waitcnt lgkmcnt(0)
    v_mfma_f32_16x16x32_bf16 v[162:165], a[96:99], v[4:7], v[162:165]
    ds_read_b64_tr_b16 a[100:101], v221 offset:0
    ds_read_b64_tr_b16 a[102:103], v221 offset:6144
    s_waitcnt lgkmcnt(0)
    v_mfma_f32_16x16x32_bf16 v[166:169], a[100:103], v[4:7], v[166:169]
    ds_read_b64_tr_b16 a[104:105], v222 offset:0
    ds_read_b64_tr_b16 a[106:107], v222 offset:6144
    ds_read_b64_tr_b16 a[108:109], v220 offset:12288
    ds_read_b64_tr_b16 a[110:111], v220 offset:18432
    ds_read_b64_tr_b16 a[112:113], v221 offset:12288
    ds_read_b64_tr_b16 a[114:115], v221 offset:18432
    ds_read_b64_tr_b16 a[116:117], v222 offset:12288
    ds_read_b64_tr_b16 a[118:119], v222 offset:18432
    s_waitcnt lgkmcnt(6)
    v_mfma_f32_16x16x32_bf16 v[170:173], a[104:107], v[4:7], v[170:173]
    buffer_load_dwordx4 v[60:63], v255, s[32:35], s75 offen offset:3072 sc1
    s_waitcnt lgkmcnt(4)
    v_mfma_f32_16x16x32_bf16 v[162:165], a[108:111], v[8:11], v[162:165]
    s_waitcnt vmcnt(13)
    s_mov_b64 exec, 2
    s_cmp_lg_u32 s97, 0
    s_cbranch_scc1 L_XS_27
    buffer_store_dword v254, v255, s[32:35], s58 offen offset:496
L_XD_28:
    s_mov_b64 exec, -1
    s_waitcnt lgkmcnt(2)
    v_mfma_f32_16x16x32_bf16 v[166:169], a[112:115], v[8:11], v[166:169]
    s_waitcnt lgkmcnt(0)
    v_mfma_f32_16x16x32_bf16 v[170:173], a[116:119], v[8:11], v[170:173]
    s_waitcnt vmcnt(9)
    s_barrier
    s_waitcnt vmcnt(8)
    v_mfma_f32_16x16x32_bf16 v[130:133], a[192:195], v[32:35], 0
    s_add_u32 m0, s52, 12288
    v_add_u32 v220, 110592, v229
    v_add_u32 v221, 110592, v230
    v_mfma_f32_16x16x32_bf16 v[134:137], a[196:199], v[32:35], 0
    buffer_load_dwordx4 v245, s[16:19], s54 offen offset:0 lds
    s_waitcnt vmcnt(8)
    v_mfma_f32_16x16x32_bf16 v[130:133], a[208:211], v[36:39], v[130:133]
    s_add_u32 m0, s52, 13184
    v_add_u32 v222, 110592, v231
    ds_read_b64_tr_b16 a[120:121], v220 offset:0
    v_mfma_f32_16x16x32_bf16 v[134:137], a[212:215], v[36:39], v[134:137]
    buffer_load_dwordx4 v245, s[16:19], s54 offen offset:128 lds
    s_waitcnt vmcnt(8)
    v_mfma_f32_16x16x32_bf16 v[130:133], a[224:227], v[40:43], v[130:133]
    s_add_u32 m0, s52, 14336
    ds_read_b64_tr_b16 a[122:123], v220 offset:6144
    ds_read_b64_tr_b16 a[124:125], v221 offset:0
    v_mfma_f32_16x16x32_bf16 v[134:137], a[228:231], v[40:43], v[134:137]
    ds_read_b64_tr_b16 a[126:127], v221 offset:6144
    ds_read_b64_tr_b16 a[128:129], v222 offset:0
    s_waitcnt vmcnt(7)
    v_mfma_f32_16x16x32_bf16 v[130:133], a[240:243], v[44:47], v[130:133]
    buffer_load_dwordx4 v244, s[16:19], s54 offen offset:0 lds
    v_mfma_f32_16x16x32_bf16 v[134:137], a[244:247], v[44:47], v[134:137]
    s_add_u32 s54, s54, 88064
    s_mul_i32 s51, s60, 360448
    s_lshl_b32 s57, s62, 7
    v_mfma_f32_16x16x32_bf16 v[138:141], a[200:203], v[32:35], 0
    ds_read_b64_tr_b16 a[130:131], v222 offset:6144
    s_add_u32 s51, s51, s57
    v_mfma_f32_16x16x32_bf16 v[142:145], a[204:207], v[32:35], 0
    ds_write_b128 v214, v[130:133] offset:32768
    v_mfma_f32_16x16x32_bf16 v[138:141], a[216:219], v[36:39], v[138:141]
    buffer_load_dword v239, v228, s[32:35], s59 offen offset:512 sc1
    v_mfma_f32_16x16x32_bf16 v[142:145], a[220:223], v[36:39], v[142:145]
    ds_write_b128 v214, v[134:137] offset:33792
    v_mfma_f32_16x16x32_bf16 v[138:141], a[232:235], v[40:43], v[138:141]
    s_bfm_b64 exec, 11, 0
    s_mul_i32 s56, s3, 11264
    buffer_load_dword v227, v223, s[20:23], s56 offen offset:384
    s_mov_b64 exec, -1
    v_mfma_f32_16x16x32_bf16 v[142:145], a[236:239], v[40:43], v[142:145]
    v_add_u32 v220, 73728, v229
    v_add_u32 v221, 73728, v230
    v_mfma_f32_16x16x32_bf16 v[138:141], a[248:251], v[44:47], v[138:141]
    v_add_u32 v222, 73728, v231
    ds_read_b64_tr_b16 a[132:133], v220 offset:0
    v_mfma_f32_16x16x32_bf16 v[142:145], a[252:255], v[44:47], v[142:145]
    s_add_u32 m0, s52, 49152
    ds_read_b64_tr_b16 a[134:135], v220 offset:6144
    ds_read_b64_tr_b16 a[136:137], v221 offset:0
    s_waitcnt vmcnt(9)
    v_mfma_f32_16x16x32_bf16 v[146:149], a[192:195], v[48:51], 0
    ds_read_b64_tr_b16 a[138:139], v221 offset:6144
    ds_read_b64_tr_b16 a[140:141], v222 offset:0
    v_mfma_f32_16x16x32_bf16 v[150:153], a[196:199], v[48:51], 0
    ds_write_b128 v215, v[138:141] offset:34816
    s_waitcnt vmcnt(8)
    v_mfma_f32_16x16x32_bf16 v[146:149], a[208:211], v[52:55], v[146:149]
    buffer_load_dwordx4 v245, s[16:19], s54 offen offset:0 lds
    v_mfma_f32_16x16x32_bf16 v[150:153], a[212:215], v[52:55], v[150:153]
    s_branch L_O3
.p2alignl 12, 0xbf810000
L_HN03:
    s_branch L_BN0
L_HU03:
    s_branch L_BU0
L_HL03:
    s_branch L_BL0
L_O3:
    ds_write_b128 v215, v[142:145] offset:35840
    s_waitcnt vmcnt(8)
    v_mfma_f32_16x16x32_bf16 v[146:149], a[224:227], v[56:59], v[146:149]
    s_add_u32 m0, s52, 50048
    ds_read_b64_tr_b16 a[142:143], v222 offset:6144
    ds_read_b64_tr_b16 a[144:145], v229 offset:0
    v_mfma_f32_16x16x32_bf16 v[150:153], a[228:231], v[56:59], v[150:153]
    buffer_load_dwordx4 v245, s[16:19], s54 offen offset:128 lds
    s_waitcnt vmcnt(8)
    v_mfma_f32_16x16x32_bf16 v[146:149], a[240:243], v[60:63], v[146:149]
    buffer_load_dword v240, v228, s[32:35], s59 offen offset:512 sc1
    v_mfma_f32_16x16x32_bf16 v[150:153], a[244:247], v[60:63], v[150:153]
    s_add_u32 m0, s52, 51200
    ds_read_b64_tr_b16 a[146:147], v229 offset:6144
    ds_read_b64_tr_b16 a[148:149], v230 offset:0
    v_mfma_f32_16x16x32_bf16 v[154:157], a[200:203], v[48:51], 0
    buffer_load_dwordx4 v244, s[16:19], s54 offen offset:0 lds
    v_mfma_f32_16x16x32_bf16 v[158:161], a[204:207], v[48:51], 0
    ds_write_b128 v216, v[146:149] offset:36864
    v_mfma_f32_16x16x32_bf16 v[154:157], a[216:219], v[52:55], v[154:157]
    s_add_u32 s54, s54, 88064
    s_add_u32 m0, s52, 61440
    ds_read_b64_tr_b16 a[150:151], v230 offset:6144
    v_mfma_f32_16x16x32_bf16 v[158:161], a[220:223], v[52:55], v[158:161]
    buffer_load_dwordx4 v245, s[16:19], s54 offen offset:0 lds
    ds_write_b128 v216, v[150:153] offset:37888
    v_mfma_f32_16x16x32_bf16 v[154:157], a[232:235], v[56:59], v[154:157]
    s_add_u32 m0, s52, 62336
    ds_read_b64_tr_b16 a[152:153], v231 offset:0
    ds_read_b64_tr_b16 a[154:155], v231 offset:6144
    v_mfma_f32_16x16x32_bf16 v[158:161], a[236:239], v[56:59], v[158:161]
    buffer_load_dwordx4 v245, s[16:19], s54 offen offset:128 lds
    v_mfma_f32_16x16x32_bf16 v[154:157], a[248:251], v[60:63], v[154:157]
    v_mfma_f32_16x16x32_bf16 v[158:161], a[252:255], v[60:63], v[158:161]
    s_waitcnt lgkmcnt(0)
    s_barrier
    ds_read_b128 v[96:99], v217 offset:32768
    ds_read_b128 v[100:103], v217 offset:33792
    ds_read_b128 v[104:107], v217 offset:34816
    ds_read_b128 v[108:111], v217 offset:35840
    ds_read_b128 v[112:115], v217 offset:36864
    ds_read_b128 v[116:119], v217 offset:37888
    s_waitcnt lgkmcnt(3)
    v_pk_add_f32 v[96:97], v[96:97], v[104:105]
    s_add_u32 m0, s52, 63488
    s_nop 0
    buffer_load_dwordx4 v244, s[16:19], s54 offen offset:0 lds
    v_pk_add_f32 v[98:99], v[98:99], v[106:107]
    s_waitcnt lgkmcnt(2)
    v_pk_add_f32 v[100:101], v[100:101], v[108:109]
    v_pk_add_f32 v[102:103], v[102:103], v[110:111]
    s_waitcnt lgkmcnt(1)
    v_pk_add_f32 v[154:155], v[154:155], v[112:113]
    s_waitcnt vmcnt(8)
    v_cmp_ne_u32 vcc, s96, v239
    s_nop 1
    s_cbranch_vccz L_WD_29
    s_waitcnt vmcnt(4)
    v_cmp_ne_u32 vcc, s96, v240
    s_nop 3
    s_cbranch_vccz L_WD_29
    s_mov_b32 s40, 20000
L_WF_31:
    v_xor_b32 v239, s96, v239
    v_cmp_lt_u32 vcc, 15, v239
    s_nop 3
    s_cbranch_vccz L_WK_32
    buffer_load_dword v239, v228, s[32:35], s59 offen offset:512 sc1
    s_waitcnt vmcnt(0)
    s_sub_u32 s40, s40, 1
    s_cbranch_scc0 L_WF_31
L_WK_32:
L_WD_29:
    v_pk_add_f32 v[156:157], v[156:157], v[114:115]
    s_waitcnt lgkmcnt(0)
    v_pk_add_f32 v[158:159], v[158:159], v[116:117]
    v_pk_add_f32 v[160:161], v[160:161], v[118:119]
    v_pk_add_f32 v[154:155], v[154:155], v[96:97]
    v_pk_add_f32 v[156:157], v[156:157], v[98:99]
    s_add_u32 m0, s84, 90112
    s_nop 0
    buffer_load_dwordx4 v255, s[32:35], s83 offen offset:0 sc1 lds
    v_pk_add_f32 v[158:159], v[158:159], v[100:101]
    v_pk_add_f32 v[160:161], v[160:161], v[102:103]
    v_pk_fma_f32 v[154:155], v[154:155], v[186:187], v[120:121]
    v_pk_fma_f32 v[156:157], v[156:157], v[188:189], v[122:123]
    v_pk_fma_f32 v[158:159], v[158:159], v[190:191], v[124:125]
    s_add_u32 m0, s84, 90112
    s_nop 0
    buffer_load_dwordx4 v255, s[32:35], s83 offen offset:1024 sc1 lds
    v_pk_fma_f32 v[160:161], v[160:161], v[192:193], v[126:127]
    v_pk_mul_f32 v[120:121], v[154:155], v[194:195]
    v_pk_mul_f32 v[122:123], v[156:157], v[196:197]
    v_pk_mul_f32 v[124:125], v[158:159], v[198:199]
    v_pk_mul_f32 v[126:127], v[160:161], v[200:201]
    v_cvt_pk_bf16_f32 v96, v120, v121
    s_add_u32 m0, s84, 90112
    s_nop 0
    buffer_load_dwordx4 v255, s[32:35], s83 offen offset:2048 sc1 lds
    v_cvt_pk_bf16_f32 v97, v122, v123
    v_cvt_pk_bf16_f32 v98, v124, v125
    v_cvt_pk_bf16_f32 v99, v126, v127
    buffer_store_dwordx4 v[96:99], v255, s[32:35], s81 offen sc1
    v_cvt_pk_bf16_f32 v210, v154, v155
    s_add_u32 m0, s84, 90112
    s_nop 0
    buffer_load_dwordx4 v255, s[32:35], s83 offen offset:3072 sc1 lds
    s_add_u32 s83, s83, 4096
    v_cvt_pk_bf16_f32 v211, v156, v157
    v_cvt_pk_bf16_f32 v212, v158, v159
    v_cvt_pk_bf16_f32 v213, v160, v161
    v_dot2c_f32_bf16 v128, s41, v210
    v_dot2c_f32_bf16 v129, v210, v210
    s_add_u32 m0, s84, 94208
    s_nop 0
    buffer_load_dwordx4 v255, s[32:35], s83 offen offset:0 sc1 lds
    v_dot2c_f32_bf16 v128, s41, v211
    v_dot2c_f32_bf16 v129, v211, v211
    v_dot2c_f32_bf16 v128, s41, v212
    v_dot2c_f32_bf16 v129, v212, v212
    v_dot2c_f32_bf16 v128, s41, v213
    v_dot2c_f32_bf16 v129, v213, v213
    s_add_u32 m0, s84, 94208
    s_nop 0
    buffer_load_dwordx4 v255, s[32:35], s83 offen offset:1024 sc1 lds
    s_cmp_ge_u32 s62, 3
    s_cselect_b32 s65, 3, 99
    s_mul_i32 s64, s60, 1536
    v_permlane32_swap_b32 v128, v129
    v_add_f32 v128, v128, v129
    v_mov_b32 v129, v128
    s_add_u32 m0, s84, 94208
    s_nop 0
    buffer_load_dwordx4 v255, s[32:35], s83 offen offset:2048 sc1 lds
    s_lshl_b32 s49, s55, 10
    s_add_u32 s64, s64, s49
    v_permlane16_swap_b32 v128, v129
    v_add_f32 v128, v128, v129
    buffer_store_dword v128, v218, s[32:35], s98 offen sc1
    ds_read_b128 v[0:3], v219 offset:640
    s_add_u32 m0, s84, 94208
    s_nop 0
    buffer_load_dwordx4 v255, s[32:35], s83 offen offset:3072 sc1 lds
    s_add_u32 s83, s83, 28672
    ds_read_b128 v[4:7], v219 offset:704
    ds_read_b128 v[8:11], v219 offset:768
    ds_read_b128 v[12:15], v219 offset:832
    ds_read_b128 v[16:19], v219 offset:896
    ds_read_b128 v[20:23], v219 offset:960
    s_add_u32 s64, s64, s47
    s_add_u32 s49, s64, 131072
    s_cmp_eq_u32 s60, s65
    s_cselect_b32 s48, 1073741824, s49
    s_lshr_b32 s57, s53, 2
    s_add_u32 m0, s57, 159744
    s_add_u32 s57, s57, s85
    buffer_load_dwordx4 v255, s[32:35], s57 offen sc1 lds
    s_add_u32 s85, s85, 4096
    v_add_u32 v160, 90112, v255
    v_lshlrev_b32 v161, 3, v241
    v_add_u32 v161, 159744, v161
    s_waitcnt vmcnt(11) lgkmcnt(0)
    s_barrier
    ds_read_b64_tr_b16 a[156:157], v229 offset:12288
    ds_read_b64_tr_b16 a[158:159], v229 offset:18432
    ds_read_b64_tr_b16 a[160:161], v230 offset:12288
    ds_read_b64_tr_b16 a[162:163], v230 offset:18432
    v_mfma_f32_16x16x32_bf16 v[162:165], a[120:123], v[0:3], v[162:165]
    ds_read_b64_tr_b16 a[164:165], v231 offset:12288
    ds_read_b64_tr_b16 a[166:167], v231 offset:18432
    v_mfma_f32_16x16x32_bf16 v[166:169], a[124:127], v[0:3], v[166:169]
    ds_read_b64_tr_b16 a[168:169], v229 offset:49152
    ds_read_b64_tr_b16 a[170:171], v229 offset:55296
    v_mfma_f32_16x16x32_bf16 v[170:173], a[128:131], v[0:3], v[170:173]
    ds_read_b64_tr_b16 a[172:173], v230 offset:49152
    ds_read_b64_tr_b16 a[174:175], v230 offset:55296
    v_mfma_f32_16x16x32_bf16 v[162:165], a[132:135], v[4:7], v[162:165]
    ds_read_b64_tr_b16 a[176:177], v231 offset:49152
    ds_read_b64_tr_b16 a[178:179], v231 offset:55296
    v_mfma_f32_16x16x32_bf16 v[166:169], a[136:139], v[4:7], v[166:169]
    v_add_u32 v220, 61440, v229
    v_add_u32 v221, 61440, v230
    v_mfma_f32_16x16x32_bf16 v[170:173], a[140:143], v[4:7], v[170:173]
    s_add_u32 m0, s53, 32768
    v_add_u32 v222, 61440, v231
    ds_read_b64_tr_b16 a[180:181], v220 offset:0
    v_mfma_f32_16x16x32_bf16 v[162:165], a[144:147], v[8:11], v[162:165]
    buffer_load_dwordx4 v250, s[20:23], s51 offen offset:0 lds
    v_mfma_f32_16x16x32_bf16 v[166:169], a[148:151], v[8:11], v[166:169]
    s_add_u32 m0, s53, 32768
    ds_read_b64_tr_b16 a[182:183], v220 offset:6144
    ds_read_b64_tr_b16 a[184:185], v221 offset:0
    v_mfma_f32_16x16x32_bf16 v[170:173], a[152:155], v[8:11], v[170:173]
    buffer_load_dwordx4 v251, s[20:23], s51 offen offset:1024 lds
    ds_read_b64_tr_b16 a[186:187], v221 offset:6144
    s_waitcnt lgkmcnt(14)
    v_mfma_f32_16x16x32_bf16 v[162:165], a[156:159], v[12:15], v[162:165]
    s_add_u32 m0, s53, 32768
    ds_read_b64_tr_b16 a[188:189], v222 offset:0
    ds_read_b64_tr_b16 a[190:191], v222 offset:6144
    s_waitcnt lgkmcnt(14)
    v_mfma_f32_16x16x32_bf16 v[166:169], a[160:163], v[12:15], v[166:169]
    buffer_load_dwordx4 v252, s[20:23], s51 offen offset:2048 lds
    s_waitcnt lgkmcnt(12)
    v_mfma_f32_16x16x32_bf16 v[170:173], a[164:167], v[12:15], v[170:173]
    s_add_u32 m0, s53, 32768
    s_waitcnt lgkmcnt(10)
    v_mfma_f32_16x16x32_bf16 v[162:165], a[168:171], v[16:19], v[162:165]
    buffer_load_dwordx4 v253, s[20:23], s51 offen offset:3072 lds
    s_waitcnt lgkmcnt(8)
    v_mfma_f32_16x16x32_bf16 v[166:169], a[172:175], v[16:19], v[166:169]
    s_add_u32 s51, s51, 32768
    s_add_u32 m0, s53, 73728
    s_waitcnt lgkmcnt(6)
    v_mfma_f32_16x16x32_bf16 v[170:173], a[176:179], v[16:19], v[170:173]
    buffer_load_dwordx4 v250, s[20:23], s51 offen offset:0 lds
    s_waitcnt lgkmcnt(4)
    v_mfma_f32_16x16x32_bf16 v[162:165], a[180:183], v[20:23], v[162:165]
    s_add_u32 m0, s53, 73728
    s_waitcnt lgkmcnt(2)
    v_mfma_f32_16x16x32_bf16 v[166:169], a[184:187], v[20:23], v[166:169]
    buffer_load_dwordx4 v251, s[20:23], s51 offen offset:1024 lds
    s_waitcnt lgkmcnt(0)
    v_mfma_f32_16x16x32_bf16 v[170:173], a[188:191], v[20:23], v[170:173]
    s_waitcnt vmcnt(14)
    s_barrier
    ds_read_b128 v[48:51], v160 offset:0
    ds_read_b128 v[52:55], v160 offset:16384
    ds_read_b128 v[56:59], v160 offset:8192
    ds_read_b128 v[60:63], v160 offset:24576
    s_waitcnt lgkmcnt(3)
    v_mfma_f32_16x16x32_bf16 v[0:3], a[0:3], v[48:51], 0
    s_add_u32 m0, s53, 73728
    ds_read_b128 v[120:123], v160 offset:1024
    v_mov_b32 v174, v162
    v_mfma_f32_16x16x32_bf16 v[4:7], a[4:7], v[48:51], 0
    buffer_load_dwordx4 v252, s[20:23], s51 offen offset:2048 lds
    v_mfma_f32_16x16x32_bf16 v[8:11], a[8:11], v[48:51], 0
    s_add_u32 m0, s53, 73728
    v_mov_b32 v175, v163
    v_mov_b32 v176, v164
    s_waitcnt lgkmcnt(3)
    v_mfma_f32_16x16x32_bf16 v[12:15], a[0:3], v[52:55], 0
    ds_read_b128 v[124:127], v160 offset:17408
    v_mov_b32 v177, v165
    v_mfma_f32_16x16x32_bf16 v[16:19], a[4:7], v[52:55], 0
    buffer_load_dwordx4 v253, s[20:23], s51 offen offset:3072 lds
    v_mfma_f32_16x16x32_bf16 v[20:23], a[8:11], v[52:55], 0
    s_waitcnt lgkmcnt(2)
    v_mov_b32 v178, v166
    v_mov_b32 v179, v167
    v_mfma_f32_16x16x32_bf16 v[0:3], a[96:99], v[56:59], v[0:3]
    s_waitcnt vmcnt(10)
    s_mov_b64 exec, 2
    s_cmp_lg_u32 s97, 0
    s_cbranch_scc1 L_XS_33
    buffer_store_dword v254, v255, s[32:35], s58 offen offset:624
L_XD_34:
    s_mov_b64 exec, -1
    v_mfma_f32_16x16x32_bf16 v[4:7], a[100:103], v[56:59], v[4:7]
    s_add_u32 s51, s51, 32768
    ds_read_b128 v[48:51], v160 offset:9216
    v_mov_b32 v180, v168
    v_mfma_f32_16x16x32_bf16 v[8:11], a[104:107], v[56:59], v[8:11]
    s_add_u32 m0, s53, 0
    v_mov_b32 v181, v169
    ds_read_b128 v[52:55], v160 offset:25600
    v_mfma_f32_16x16x32_bf16 v[12:15], a[96:99], v[60:63], v[12:15]
    buffer_load_dwordx4 v250, s[20:23], s51 offen offset:0 lds
    v_mfma_f32_16x16x32_bf16 v[16:19], a[100:103], v[60:63], v[16:19]
    s_add_u32 m0, s53, 0
    v_mov_b32 v182, v170
    v_mov_b32 v183, v171
    v_mfma_f32_16x16x32_bf16 v[20:23], a[104:107], v[60:63], v[20:23]
    s_waitcnt lgkmcnt(2)
    v_mov_b32 v184, v172
    v_mov_b32 v185, v173
    v_mfma_f32_16x16x32_bf16 v[0:3], a[12:15], v[120:123], v[0:3]
    buffer_load_dwordx4 v251, s[20:23], s51 offen offset:1024 lds
    v_mfma_f32_16x16x32_bf16 v[4:7], a[16:19], v[120:123], v[4:7]
    ds_read_b128 v[56:59], v160 offset:2048
    v_mov_b32_dpp v174, v162 row_ror:8 row_mask:0xf bank_mask:0x3
    v_mfma_f32_16x16x32_bf16 v[8:11], a[20:23], v[120:123], v[8:11]
    s_add_u32 m0, s53, 0
    v_mov_b32_dpp v175, v163 row_ror:8 row_mask:0xf bank_mask:0x3
    ds_read_b128 v[60:63], v160 offset:18432
    v_mfma_f32_16x16x32_bf16 v[12:15], a[12:15], v[124:127], v[12:15]
    buffer_load_dwordx4 v252, s[20:23], s51 offen offset:2048 lds
    v_mfma_f32_16x16x32_bf16 v[16:19], a[16:19], v[124:127], v[16:19]
    s_add_u32 m0, s53, 0
    v_mov_b32_dpp v176, v164 row_ror:8 row_mask:0xf bank_mask:0x3
    v_mov_b32_dpp v177, v165 row_ror:8 row_mask:0xf bank_mask:0x3
    v_mfma_f32_16x16x32_bf16 v[20:23], a[20:23], v[124:127], v[20:23]
    s_waitcnt lgkmcnt(2)
    v_mov_b32_dpp v178, v166 row_ror:8 row_mask:0xf bank_mask:0x3
    v_mov_b32_dpp v179, v167 row_ror:8 row_mask:0xf bank_mask:0x3
    v_mfma_f32_16x16x32_bf16 v[0:3], a[108:111], v[48:51], v[0:3]
    buffer_load_dwordx4 v253, s[20:23], s51 offen offset:3072 lds
    v_mfma_f32_16x16x32_bf16 v[4:7], a[112:115], v[48:51], v[4:7]
    s_add_u32 s51, s51, 32768
    ds_read_b128 v[120:123], v160 offset:10240
    v_mov_b32_dpp v180, v168 row_ror:8 row_mask:0xf bank_mask:0x3
    v_mfma_f32_16x16x32_bf16 v[8:11], a[116:119], v[48:51], v[8:11]
    s_add_u32 m0, s53, 16384
    ds_read_b128 v[124:127], v160 offset:26624
    v_mov_b32_dpp v181, v169 row_ror:8 row_mask:0xf bank_mask:0x3
    v_mfma_f32_16x16x32_bf16 v[12:15], a[108:111], v[52:55], v[12:15]
    v_mov_b32_dpp v182, v170 row_ror:8 row_mask:0xf bank_mask:0x3
    v_mov_b32_dpp v183, v171 row_ror:8 row_mask:0xf bank_mask:0x3
    v_mfma_f32_16x16x32_bf16 v[16:19], a[112:115], v[52:55], v[16:19]
    buffer_load_dwordx4 v250, s[20:23], s51 offen offset:0 lds
    v_mfma_f32_16x16x32_bf16 v[20:23], a[116:119], v[52:55], v[20:23]
    s_waitcnt lgkmcnt(2)
    v_mov_b32_dpp v184, v172 row_ror:8 row_mask:0xf bank_mask:0x3
    s_add_u32 m0, s53, 16384
    v_mfma_f32_16x16x32_bf16 v[0:3], a[24:27], v[56:59], v[0:3]
    s_waitcnt vmcnt(14) lgkmcnt(0)
    s_barrier
    v_mfma_f32_16x16x32_bf16 v[4:7], a[28:31], v[56:59], v[4:7]
    buffer_load_dwordx4 v251, s[20:23], s51 offen offset:1024 lds
    v_mfma_f32_16x16x32_bf16 v[8:11], a[32:35], v[56:59], v[8:11]
    ds_read_b128 v[48:51], v160 offset:3072
    ds_read2st64_b64 v[64:67], v161 offset0:0 offset1:1
    v_mfma_f32_16x16x32_bf16 v[12:15], a[24:27], v[60:63], v[12:15]
    v_mov_b32_dpp v185, v173 row_ror:8 row_mask:0xf bank_mask:0x3
    v_mov_b32_dpp v162, v162 row_ror:8 row_mask:0xf bank_mask:0xc
    v_mfma_f32_16x16x32_bf16 v[16:19], a[28:31], v[60:63], v[16:19]
    buffer_load_dword v239, v228, s[32:35], s59 offen offset:640 sc1
    ds_read_b128 v[52:55], v160 offset:19456
    v_mfma_f32_16x16x32_bf16 v[20:23], a[32:35], v[60:63], v[20:23]
    ds_read2st64_b64 v[68:71], v161 offset0:2 offset1:3
    v_mov_b32_dpp v163, v163 row_ror:8 row_mask:0xf bank_mask:0xc
    v_mfma_f32_16x16x32_bf16 v[0:3], a[120:123], v[120:123], v[0:3]
    s_add_u32 m0, s53, 16384
    v_mov_b32_dpp v164, v164 row_ror:8 row_mask:0xf bank_mask:0xc
    ds_read2st64_b64 v[72:75], v161 offset0:4 offset1:5
    v_mfma_f32_16x16x32_bf16 v[4:7], a[124:127], v[120:123], v[4:7]
    buffer_load_dwordx4 v252, s[20:23], s51 offen offset:2048 lds
    v_mfma_f32_16x16x32_bf16 v[8:11], a[128:131], v[120:123], v[8:11]
    s_add_u32 m0, s53, 16384
    ds_read_b128 v[56:59], v160 offset:11264
    v_mov_b32_dpp v165, v165 row_ror:8 row_mask:0xf bank_mask:0xc
    ds_read2st64_b64 v[76:79], v161 offset0:6 offset1:7
    v_mfma_f32_16x16x32_bf16 v[12:15], a[120:123], v[124:127], v[12:15]
    buffer_load_dwordx4 v253, s[20:23], s51 offen offset:3072 lds
    v_mfma_f32_16x16x32_bf16 v[16:19], a[124:127], v[124:127], v[16:19]
    s_add_u32 s51, s51, 32768
    v_mov_b32_dpp v166, v166 row_ror:8 row_mask:0xf bank_mask:0xc
    v_mov_b32_dpp v167, v167 row_ror:8 row_mask:0xf bank_mask:0xc
    ds_read_b128 v[60:63], v160 offset:27648
    v_mfma_f32_16x16x32_bf16 v[20:23], a[128:131], v[124:127], v[20:23]
    s_waitcnt lgkmcnt(5)
    v_mov_b32_dpp v168, v168 row_ror:8 row_mask:0xf bank_mask:0xc
    v_mov_b32_dpp v169, v169 row_ror:8 row_mask:0xf bank_mask:0xc
    v_mfma_f32_16x16x32_bf16 v[0:3], a[36:39], v[48:51], v[0:3]
    s_add_u32 m0, s53, 49152
    v_mov_b32_dpp v170, v170 row_ror:8 row_mask:0xf bank_mask:0xc
    ds_read_b128 v[120:123], v160 offset:4096
    v_mfma_f32_16x16x32_bf16 v[4:7], a[40:43], v[48:51], v[4:7]
    buffer_load_dwordx4 v250, s[20:23], s51 offen offset:0 lds
    v_mfma_f32_16x16x32_bf16 v[8:11], a[44:47], v[48:51], v[8:11]
    buffer_load_dword v240, v228, s[32:35], s59 offen offset:640 sc1
    v_mfma_f32_16x16x32_bf16 v[12:15], a[36:39], v[52:55], v[12:15]
    s_add_u32 m0, s53, 49152
    v_mov_b32_dpp v171, v171 row_ror:8 row_mask:0xf bank_mask:0xc
    v_mov_b32_dpp v172, v172 row_ror:8 row_mask:0xf bank_mask:0xc
    v_mov_b32_dpp v173, v173 row_ror:8 row_mask:0xf bank_mask:0xc
    v_mfma_f32_16x16x32_bf16 v[16:19], a[40:43], v[52:55], v[16:19]
    buffer_load_dwordx4 v251, s[20:23], s51 offen offset:1024 lds
    ds_read_b128 v[124:127], v160 offset:20480
    v_mfma_f32_16x16x32_bf16 v[20:23], a[44:47], v[52:55], v[20:23]
    s_waitcnt lgkmcnt(2)
    v_add_f32 v64, v64, v66
    v_add_f32 v65, v65, v67
    v_mfma_f32_16x16x32_bf16 v[0:3], a[132:135], v[56:59], v[0:3]
    s_waitcnt vmcnt(17)
    v_add_f32 v68, v68, v70
    ds_read_b128 v[48:51], v160 offset:12288
    v_mfma_f32_16x16x32_bf16 v[4:7], a[136:139], v[56:59], v[4:7]
    ds_read_b64_tr_b16 a[192:193], v225 offset:32768
    v_add_f32 v69, v69, v71
    v_mfma_f32_16x16x32_bf16 v[8:11], a[140:143], v[56:59], v[8:11]
    ds_read_b64_tr_b16 a[194:195], v225 offset:34816
    v_add_f32 v64, v64, v68
    v_mfma_f32_16x16x32_bf16 v[12:15], a[132:135], v[60:63], v[12:15]
    ds_read_b64_tr_b16 a[196:197], v225 offset:32776
    ds_read_b64_tr_b16 a[198:199], v225 offset:34824
    v_mfma_f32_16x16x32_bf16 v[16:19], a[136:139], v[60:63], v[16:19]
    v_add_f32 v65, v65, v69
    ds_read_b128 v[52:55], v160 offset:28672
    v_mfma_f32_16x16x32_bf16 v[20:23], a[140:143], v[60:63], v[20:23]
    s_waitcnt lgkmcnt(6)
    ds_read_b64_tr_b16 a[200:201], v226 offset:32768
    ds_read_b64_tr_b16 a[202:203], v226 offset:34816
    v_mfma_f32_16x16x32_bf16 v[0:3], a[48:51], v[120:123], v[0:3]
    v_add_f32 v72, v72, v74
    ds_read_b64_tr_b16 a[204:205], v226 offset:32776
    v_mfma_f32_16x16x32_bf16 v[4:7], a[52:55], v[120:123], v[4:7]
    v_add_f32 v73, v73, v75
    ds_read_b64_tr_b16 a[206:207], v226 offset:34824
    v_mfma_f32_16x16x32_bf16 v[8:11], a[56:59], v[120:123], v[8:11]
    s_add_u32 m0, s53, 49152
    v_add_f32 v76, v76, v78
    v_add_f32 v77, v77, v79
    ds_read_b128 v[56:59], v160 offset:5120
    v_mfma_f32_16x16x32_bf16 v[12:15], a[48:51], v[124:127], v[12:15]
    buffer_load_dwordx4 v252, s[20:23], s51 offen offset:2048 lds
    v_mfma_f32_16x16x32_bf16 v[16:19], a[52:55], v[124:127], v[16:19]
    s_add_u32 m0, s53, 49152
    v_add_f32 v72, v72, v76
    v_add_f32 v73, v73, v77
    ds_read_b128 v[60:63], v160 offset:21504
    v_mfma_f32_16x16x32_bf16 v[20:23], a[56:59], v[124:127], v[20:23]
    s_waitcnt lgkmcnt(6)
    v_permlane32_swap_b32 v64, v72
    buffer_load_dwordx4 v253, s[20:23], s51 offen offset:3072 lds
    v_mfma_f32_16x16x32_bf16 v[0:3], a[144:147], v[48:51], v[0:3]
    s_add_u32 s51, s51, 32768
    s_waitcnt lgkmcnt(2)
    s_add_u32 m0, s53, 32768
    v_mfma_f32_16x16x32_bf16 v[4:7], a[148:151], v[48:51], v[4:7]
    buffer_load_dwordx4 v250, s[20:23], s51 offen offset:0 lds
    s_add_u32 m0, s53, 32768
    s_nop 0
    buffer_load_dwordx4 v251, s[20:23], s51 offen offset:1024 lds
    v_mfma_f32_16x16x32_bf16 v[8:11], a[152:155], v[48:51], v[8:11]
    v_permlane32_swap_b32 v65, v73
    ds_read_b128 v[120:123], v160 offset:13312
    v_mfma_f32_16x16x32_bf16 v[12:15], a[144:147], v[52:55], v[12:15]
    v_add_f32 v64, v64, v72
    v_add_f32 v65, v65, v73
    v_mfma_f32_16x16x32_bf16 v[16:19], a[148:151], v[52:55], v[16:19]
    v_mov_b32 v72, v64
    v_mov_b32 v73, v65
    ds_read_b128 v[124:127], v160 offset:29696
    v_mfma_f32_16x16x32_bf16 v[20:23], a[152:155], v[52:55], v[20:23]
    s_waitcnt lgkmcnt(2)
    v_permlane16_swap_b32 v64, v72
    s_waitcnt vmcnt(9)
    v_cmp_ne_u32 vcc, s96, v239
    s_nop 1
    s_cbranch_vccz L_WD_35
    s_waitcnt vmcnt(5)
    v_cmp_ne_u32 vcc, s96, v240
    s_nop 3
    s_cbranch_vccz L_WD_35
    s_mov_b32 s40, 20000
L_WF_37:
    v_xor_b32 v239, s96, v239
    v_cmp_lt_u32 vcc, 15, v239
    s_nop 3
    s_cbranch_vccz L_WK_38
    buffer_load_dword v239, v228, s[32:35], s59 offen offset:640 sc1
    s_waitcnt vmcnt(0)
    s_sub_u32 s40, s40, 1
    s_cbranch_scc0 L_WF_37
L_WK_38:
L_WD_35:
    v_mfma_f32_16x16x32_bf16 v[0:3], a[60:63], v[56:59], v[0:3]
    s_add_u32 m0, s84, 122880
    v_permlane16_swap_b32 v65, v73
    s_waitcnt lgkmcnt(0)
    s_barrier
    v_mfma_f32_16x16x32_bf16 v[4:7], a[64:67], v[56:59], v[4:7]
    buffer_load_dwordx4 v255, s[32:35], s83 offen offset:0 sc1 lds
    v_mfma_f32_16x16x32_bf16 v[8:11], a[68:71], v[56:59], v[8:11]
    s_add_u32 m0, s84, 122880
    v_add_f32 v64, v64, v72
    ds_read_b128 v[48:51], v160 offset:6144
    v_mfma_f32_16x16x32_bf16 v[12:15], a[60:63], v[60:63], v[12:15]
    buffer_load_dwordx4 v255, s[32:35], s83 offen offset:1024 sc1 lds
    v_mfma_f32_16x16x32_bf16 v[16:19], a[64:67], v[60:63], v[16:19]
    v_add_f32 v65, v65, v73
    v_mul_f32 v64, 0x3b000000, v64
    ds_read_b128 v[52:55], v160 offset:22528
    v_mfma_f32_16x16x32_bf16 v[20:23], a[68:71], v[60:63], v[20:23]
    v_mul_f32 v65, 0x3b000000, v65
    v_fma_f32 v65, -v64, v64, v65
    v_mfma_f32_16x16x32_bf16 v[0:3], a[156:159], v[120:123], v[0:3]
    s_add_u32 m0, s84, 122880
    v_max_f32 v65, 0, v65
    v_add_f32 v65, 0x3727c5ac, v65
    v_mfma_f32_16x16x32_bf16 v[4:7], a[160:163], v[120:123], v[4:7]
    buffer_load_dwordx4 v255, s[32:35], s83 offen offset:2048 sc1 lds
    v_mfma_f32_16x16x32_bf16 v[8:11], a[164:167], v[120:123], v[8:11]
    ds_read_b128 v[56:59], v160 offset:14336
    ds_read_b128 v[60:63], v160 offset:30720
    v_mfma_f32_16x16x32_bf16 v[12:15], a[156:159], v[124:127], v[12:15]
    s_add_u32 m0, s84, 122880
    v_rsq_f32 v65, v65
    v_mfma_f32_16x16x32_bf16 v[16:19], a[160:163], v[124:127], v[16:19]
    v_mul_f32_e64 v64, -v64, v65
    v_mov_b32 v73, v65
    v_mfma_f32_16x16x32_bf16 v[20:23], a[164:167], v[124:127], v[20:23]
    s_waitcnt lgkmcnt(2)
    v_mov_b32 v72, v64
    v_mfma_f32_16x16x32_bf16 v[0:3], a[72:75], v[48:51], v[0:3]
    buffer_load_dwordx4 v255, s[32:35], s83 offen offset:3072 sc1 lds
    v_mfma_f32_16x16x32_bf16 v[4:7], a[76:79], v[48:51], v[4:7]
    s_add_u32 s83, s83, 4096
    v_permlane32_swap_b32 v65, v73
    v_mfma_f32_16x16x32_bf16 v[8:11], a[80:83], v[48:51], v[8:11]
    s_add_u32 m0, s84, 126976
    ds_read_b128 v[120:123], v160 offset:7168
    ds_read_b128 v[124:127], v160 offset:23552
    v_mfma_f32_16x16x32_bf16 v[12:15], a[72:75], v[52:55], v[12:15]
    buffer_load_dwordx4 v255, s[32:35], s83 offen offset:0 sc1 lds
    v_mfma_f32_16x16x32_bf16 v[16:19], a[76:79], v[52:55], v[16:19]
    v_permlane32_swap_b32 v64, v72
    v_mfma_f32_16x16x32_bf16 v[20:23], a[80:83], v[52:55], v[20:23]
    s_waitcnt lgkmcnt(2)
    v_fma_f32 v96, v64, v162, v174
    v_fma_f32 v97, v64, v163, v175
    v_mfma_f32_16x16x32_bf16 v[0:3], a[168:171], v[56:59], v[0:3]
    s_add_u32 m0, s84, 126976
    v_fma_f32 v98, v64, v164, v176
    v_fma_f32 v99, v64, v165, v177
    v_mfma_f32_16x16x32_bf16 v[4:7], a[172:175], v[56:59], v[4:7]
    buffer_load_dwordx4 v255, s[32:35], s83 offen offset:1024 sc1 lds
    v_mfma_f32_16x16x32_bf16 v[8:11], a[176:179], v[56:59], v[8:11]
    v_fma_f32 v100, v64, v166, v178
    ds_read_b128 v[48:51], v160 offset:15360
    v_mfma_f32_16x16x32_bf16 v[12:15], a[168:171], v[60:63], v[12:15]
    s_add_u32 m0, s84, 126976
    v_fma_f32 v101, v64, v167, v179
    v_fma_f32 v102, v64, v168, v180
    v_mfma_f32_16x16x32_bf16 v[16:19], a[172:175], v[60:63], v[16:19]
    v_fma_f32 v103, v64, v169, v181
    ds_read_b128 v[52:55], v160 offset:31744
    v_mfma_f32_16x16x32_bf16 v[20:23], a[176:179], v[60:63], v[20:23]
    s_waitcnt lgkmcnt(2)
    v_fma_f32 v104, v64, v170, v182
    v_fma_f32 v105, v64, v171, v183
    v_mfma_f32_16x16x32_bf16 v[0:3], a[84:87], v[120:123], v[0:3]
    buffer_load_dwordx4 v255, s[32:35], s83 offen offset:2048 sc1 lds
    v_mfma_f32_16x16x32_bf16 v[4:7], a[88:91], v[120:123], v[4:7]
    s_add_u32 m0, s84, 126976
    v_fma_f32 v106, v64, v172, v184
    v_fma_f32 v107, v64, v173, v185
    v_mfma_f32_16x16x32_bf16 v[8:11], a[92:95], v[120:123], v[8:11]
    v_fma_f32 v108, v72, v162, v174
    v_fma_f32 v109, v72, v163, v175
    v_mfma_f32_16x16x32_bf16 v[12:15], a[84:87], v[124:127], v[12:15]
    buffer_load_dwordx4 v255, s[32:35], s83 offen offset:3072 sc1 lds
    v_mfma_f32_16x16x32_bf16 v[16:19], a[88:91], v[124:127], v[16:19]
    v_fma_f32 v110, v72, v164, v176
    v_fma_f32 v111, v72, v165, v177
    v_mfma_f32_16x16x32_bf16 v[20:23], a[92:95], v[124:127], v[20:23]
    s_waitcnt lgkmcnt(0)
    v_fma_f32 v112, v72, v166, v178
    v_fma_f32 v113, v72, v167, v179
    v_mfma_f32_16x16x32_bf16 v[0:3], a[180:183], v[48:51], v[0:3]
    s_lshr_b32 s57, s53, 2
    v_fma_f32 v114, v72, v168, v180
    v_fma_f32 v115, v72, v169, v181
    v_mfma_f32_16x16x32_bf16 v[4:7], a[184:187], v[48:51], v[4:7]
    s_add_u32 m0, s57, 159744
    v_fma_f32 v116, v72, v170, v182
    s_add_u32 s57, s57, s85
    v_mfma_f32_16x16x32_bf16 v[8:11], a[188:191], v[48:51], v[8:11]
    v_fma_f32 v117, v72, v171, v183
    v_fma_f32 v118, v72, v172, v184
    v_mfma_f32_16x16x32_bf16 v[12:15], a[180:183], v[52:55], v[12:15]
    buffer_load_dwordx4 v255, s[32:35], s57 offen sc1 lds
    v_mfma_f32_16x16x32_bf16 v[16:19], a[184:187], v[52:55], v[16:19]
    v_fma_f32 v119, v72, v173, v185
    v_mfma_f32_16x16x32_bf16 v[20:23], a[188:191], v[52:55], v[20:23]
    v_pk_fma_f32 v[0:1], v[0:1], v[64:65], v[96:97] op_sel:[0,1,0] op_sel_hi:[1,1,1]
    s_add_u32 m0, s53, 32768
    s_nop 0
    buffer_load_dwordx4 v252, s[20:23], s51 offen offset:2048 lds
    v_pk_fma_f32 v[2:3], v[2:3], v[64:65], v[98:99] op_sel:[0,1,0] op_sel_hi:[1,1,1]
    v_cvt_pk_bf16_f32 v96, v0, v1
    v_cvt_pk_bf16_f32 v97, v2, v3
    v_pk_fma_f32 v[12:13], v[12:13], v[72:73], v[108:109] op_sel:[0,1,0] op_sel_hi:[1,1,1]
    v_pk_fma_f32 v[14:15], v[14:15], v[72:73], v[110:111] op_sel:[0,1,0] op_sel_hi:[1,1,1]
    v_cvt_pk_bf16_f32 v98, v12, v13
    v_cvt_pk_bf16_f32 v99, v14, v15
    v_pk_max_i16 v96, v96, 0
    v_pk_max_i16 v98, v98, 0
    v_pk_max_i16 v97, v97, 0
    v_pk_max_i16 v99, v99, 0
    v_permlane16_swap_b32 v96, v98
    s_nop 0
    v_permlane16_swap_b32 v97, v99
    buffer_store_dwordx4 v[96:99], v232, s[32:35], s49 offen offset:0 sc1
    v_pk_fma_f32 v[4:5], v[4:5], v[64:65], v[100:101] op_sel:[0,1,0] op_sel_hi:[1,1,1]
    v_pk_fma_f32 v[6:7], v[6:7], v[64:65], v[102:103] op_sel:[0,1,0] op_sel_hi:[1,1,1]
    v_cvt_pk_bf16_f32 v100, v4, v5
    v_cvt_pk_bf16_f32 v101, v6, v7
    v_pk_fma_f32 v[16:17], v[16:17], v[72:73], v[112:113] op_sel:[0,1,0] op_sel_hi:[1,1,1]
    v_pk_fma_f32 v[18:19], v[18:19], v[72:73], v[114:115] op_sel:[0,1,0] op_sel_hi:[1,1,1]
    v_cvt_pk_bf16_f32 v102, v16, v17
    v_cvt_pk_bf16_f32 v103, v18, v19
    v_pk_max_i16 v100, v100, 0
    s_add_u32 m0, s53, 32768
    s_nop 0
    s_branch L_O4
.p2alignl 12, 0xbf810000
L_HN10:
    s_branch L_BN1
L_HU10:
    s_branch L_BU1
L_HL10:
    s_branch L_BL1
L_O4:
    buffer_load_dwordx4 v253, s[20:23], s51 offen offset:3072 lds
    s_add_u32 s51, s51, 32768
    v_pk_max_i16 v102, v102, 0
    v_pk_max_i16 v101, v101, 0
    v_pk_max_i16 v103, v103, 0
    v_permlane16_swap_b32 v100, v102
    s_nop 0
    v_permlane16_swap_b32 v101, v103
    buffer_store_dwordx4 v[100:103], v232, s[32:35], s48 offen offset:512 sc1
    v_pk_fma_f32 v[8:9], v[8:9], v[64:65], v[104:105] op_sel:[0,1,0] op_sel_hi:[1,1,1]
    v_pk_fma_f32 v[10:11], v[10:11], v[64:65], v[106:107] op_sel:[0,1,0] op_sel_hi:[1,1,1]
    v_cvt_pk_bf16_f32 v104, v8, v9
    v_cvt_pk_bf16_f32 v105, v10, v11
    v_pk_fma_f32 v[20:21], v[20:21], v[72:73], v[116:117] op_sel:[0,1,0] op_sel_hi:[1,1,1]
    v_pk_fma_f32 v[22:23], v[22:23], v[72:73], v[118:119] op_sel:[0,1,0] op_sel_hi:[1,1,1]
    v_cvt_pk_bf16_f32 v106, v20, v21
    v_cvt_pk_bf16_f32 v107, v22, v23
    v_pk_max_i16 v104, v104, 0
    v_pk_max_i16 v106, v106, 0
    v_pk_max_i16 v105, v105, 0
    v_pk_max_i16 v107, v107, 0
    v_permlane16_swap_b32 v104, v106
    s_nop 0
    v_permlane16_swap_b32 v105, v107
    buffer_store_dwordx4 v[104:107], v232, s[32:35], s48 offen offset:1024 sc1
    s_add_u32 s49, s49, 90112
    s_add_u32 s48, s48, 90112
    s_waitcnt vmcnt(11)
    s_barrier
    ds_read_b128 v[56:59], v160 offset:32768
    ds_read_b128 v[60:63], v160 offset:49152
    ds_read_b128 v[120:123], v160 offset:40960
    ds_read_b128 v[124:127], v160 offset:57344
    s_waitcnt lgkmcnt(3)
    v_mfma_f32_16x16x32_bf16 v[24:27], a[0:3], v[56:59], 0
    s_cmp_eq_u32 s79, 1021
    s_cbranch_scc1 L_SD_43
L_SX_44:
    ds_read_b128 v[48:51], v160 offset:33792
    v_mfma_f32_16x16x32_bf16 v[28:31], a[4:7], v[56:59], 0
    v_add_u32 v220, 73728, v225
    v_add_u32 v221, 73728, v226
    v_mfma_f32_16x16x32_bf16 v[32:35], a[8:11], v[56:59], 0
    s_mul_i32 s72, s60, 11264
    ds_read_b64_tr_b16 a[208:209], v220 offset:0
    ds_read_b64_tr_b16 a[210:211], v220 offset:2048
    s_waitcnt lgkmcnt(5)
    v_mfma_f32_16x16x32_bf16 v[36:39], a[0:3], v[60:63], 0
    ds_read_b64_tr_b16 a[212:213], v220 offset:8
    ds_read_b128 v[52:55], v160 offset:50176
    v_mfma_f32_16x16x32_bf16 v[40:43], a[4:7], v[60:63], 0
    s_add_u32 s72, s72, s47
    ds_read_b64_tr_b16 a[214:215], v220 offset:2056
    ds_read_b64_tr_b16 a[216:217], v221 offset:0
    v_mfma_f32_16x16x32_bf16 v[44:47], a[8:11], v[60:63], 0
    s_waitcnt lgkmcnt(7)
    ds_read_b64_tr_b16 a[218:219], v221 offset:2048
    ds_read_b64_tr_b16 a[220:221], v221 offset:8
    v_mfma_f32_16x16x32_bf16 v[24:27], a[96:99], v[120:123], v[24:27]
    s_add_u32 s72, s72, 131072
    ds_read_b64_tr_b16 a[222:223], v221 offset:2056
    v_mfma_f32_16x16x32_bf16 v[28:31], a[100:103], v[120:123], v[28:31]
    s_lshr_b32 s74, s60, 1
    ds_read_b64_tr_b16 a[224:225], v225 offset:0
    ds_read_b64_tr_b16 a[226:227], v225 offset:2048
    v_mfma_f32_16x16x32_bf16 v[32:35], a[104:107], v[120:123], v[32:35]
    ds_read_b64_tr_b16 a[228:229], v225 offset:8
    ds_read_b128 v[56:59], v160 offset:41984
    v_mfma_f32_16x16x32_bf16 v[36:39], a[96:99], v[124:127], v[36:39]
    s_mul_i32 s74, s74, 45056
    ds_read_b64_tr_b16 a[230:231], v225 offset:2056
    ds_read_b64_tr_b16 a[232:233], v226 offset:0
    v_mfma_f32_16x16x32_bf16 v[40:43], a[100:103], v[124:127], v[40:43]
    ds_read_b64_tr_b16 a[234:235], v226 offset:2048
    ds_read_b64_tr_b16 a[236:237], v226 offset:8
    ds_read_b128 v[60:63], v160 offset:58368
    v_mfma_f32_16x16x32_bf16 v[44:47], a[104:107], v[124:127], v[44:47]
    s_waitcnt lgkmcnt(14)
    ds_read_b64_tr_b16 a[238:239], v226 offset:2056
    s_waitcnt lgkmcnt(10)
    v_mfma_f32_16x16x32_bf16 v[24:27], a[12:15], v[48:51], v[24:27]
    s_add_u32 m0, s53, 73728
    ds_read_b128 v[120:123], v160 offset:34816
    s_add_u32 s73, s72, s74
    v_mfma_f32_16x16x32_bf16 v[28:31], a[16:19], v[48:51], v[28:31]
    buffer_load_dwordx4 v250, s[20:23], s51 offen offset:0 lds
    v_mfma_f32_16x16x32_bf16 v[32:35], a[20:23], v[48:51], v[32:35]
    s_add_u32 m0, s53, 73728
    s_sub_u32 s72, s72, s74
    ds_read_b128 v[124:127], v160 offset:51200
    buffer_load_dwordx4 v251, s[20:23], s51 offen offset:1024 lds
    v_mfma_f32_16x16x32_bf16 v[36:39], a[12:15], v[52:55], v[36:39]
    s_add_u32 m0, s53, 73728
    s_add_u32 s72, s72, 45056
    s_add_u32 s74, s72, 90112
    buffer_load_dwordx4 v252, s[20:23], s51 offen offset:2048 lds
    s_add_u32 m0, s53, 73728
    s_nop 0
    buffer_load_dwordx4 v253, s[20:23], s51 offen offset:3072 lds
    s_add_u32 s51, s51, 32768
    v_mfma_f32_16x16x32_bf16 v[40:43], a[16:19], v[52:55], v[40:43]
    ds_read_b64_tr_b16 a[240:241], v225 offset:16384
    ds_read_b64_tr_b16 a[242:243], v225 offset:18432
    v_mfma_f32_16x16x32_bf16 v[44:47], a[20:23], v[52:55], v[44:47]
    s_waitcnt lgkmcnt(5)
    ds_read_b64_tr_b16 a[244:245], v225 offset:16392
    ds_read_b64_tr_b16 a[246:247], v225 offset:18440
    v_mfma_f32_16x16x32_bf16 v[24:27], a[108:111], v[56:59], v[24:27]
    s_add_u32 s75, s73, 90112
    ds_read_b128 v[48:51], v160 offset:43008
    ds_read_b64_tr_b16 a[248:249], v226 offset:16384
    v_mfma_f32_16x16x32_bf16 v[28:31], a[112:115], v[56:59], v[28:31]
    s_cmp_eq_u32 s60, 3
    s_cselect_b32 s76, 1073741824, 0
    ds_read_b64_tr_b16 a[250:251], v226 offset:18432
    v_mfma_f32_16x16x32_bf16 v[32:35], a[116:119], v[56:59], v[32:35]
    ds_read_b64_tr_b16 a[252:253], v226 offset:16392
    ds_read_b128 v[52:55], v160 offset:59392
    v_mfma_f32_16x16x32_bf16 v[36:39], a[108:111], v[60:63], v[36:39]
    ds_read_b64_tr_b16 a[254:255], v226 offset:18440
    s_waitcnt lgkmcnt(12)
    v_mfma_f32_16x16x32_bf16 v[40:43], a[112:115], v[60:63], v[40:43]
    s_add_u32 m0, s53, 0
    v_mfma_f32_16x16x32_bf16 v[44:47], a[116:119], v[60:63], v[44:47]
    s_waitcnt lgkmcnt(10)
    v_mfma_f32_16x16x32_bf16 v[24:27], a[24:27], v[120:123], v[24:27]
    buffer_load_dwordx4 v250, s[20:23], s51 offen offset:0 lds
    s_waitcnt vmcnt(10) lgkmcnt(0)
    s_barrier
    v_mfma_f32_16x16x32_bf16 v[28:31], a[28:31], v[120:123], v[28:31]
    s_add_u32 m0, s53, 0
    ds_read_b128 v[56:59], v160 offset:35840
    ds_read2st64_b64 v[80:83], v161 offset0:0 offset1:1
    v_mfma_f32_16x16x32_bf16 v[32:35], a[32:35], v[120:123], v[32:35]
    buffer_load_dwordx4 v251, s[20:23], s51 offen offset:1024 lds
    v_mfma_f32_16x16x32_bf16 v[36:39], a[24:27], v[124:127], v[36:39]
    s_add_u32 m0, s53, 0
    ds_read2st64_b64 v[84:87], v161 offset0:2 offset1:3
    ds_read_b128 v[60:63], v160 offset:52224
    v_mfma_f32_16x16x32_bf16 v[40:43], a[28:31], v[124:127], v[40:43]
    buffer_load_dwordx4 v252, s[20:23], s51 offen offset:2048 lds
    v_mfma_f32_16x16x32_bf16 v[44:47], a[32:35], v[124:127], v[44:47]
    ds_read2st64_b64 v[88:91], v161 offset0:4 offset1:5
    s_add_u32 m0, s53, 0
    v_mfma_f32_16x16x32_bf16 v[24:27], a[120:123], v[48:51], v[24:27]
    buffer_load_dwordx4 v253, s[20:23], s51 offen offset:3072 lds
    ds_read2st64_b64 v[92:95], v161 offset0:6 offset1:7
    s_waitcnt vmcnt(8)
    s_mov_b64 exec, 2
    s_cmp_lg_u32 s97, 0
    s_cbranch_scc1 L_XS_45
    buffer_store_dword v254, v255, s[32:35], s58 offen offset:752
L_XD_46:
    s_mov_b64 exec, -1
    v_mfma_f32_16x16x32_bf16 v[28:31], a[124:127], v[48:51], v[28:31]
    s_add_u32 s51, s51, 32768
    ds_read_b128 v[120:123], v160 offset:44032
    ds_read_b128 v[124:127], v160 offset:60416
    v_mfma_f32_16x16x32_bf16 v[32:35], a[128:131], v[48:51], v[32:35]
    ds_read_b64_tr_b16 v[128:129], v225 offset:49152
    ds_read_b64_tr_b16 v[130:131], v225 offset:51200
    v_mfma_f32_16x16x32_bf16 v[36:39], a[120:123], v[52:55], v[36:39]
    ds_read_b64_tr_b16 v[132:133], v225 offset:49160
    ds_read_b64_tr_b16 v[134:135], v225 offset:51208
    v_mfma_f32_16x16x32_bf16 v[40:43], a[124:127], v[52:55], v[40:43]
    s_waitcnt lgkmcnt(10)
    v_add_f32 v80, v80, v82
    v_add_f32 v81, v81, v83
    v_mfma_f32_16x16x32_bf16 v[44:47], a[128:131], v[52:55], v[44:47]
    s_waitcnt lgkmcnt(8)
    ds_read_b64_tr_b16 v[136:137], v226 offset:49152
    ds_read_b64_tr_b16 v[138:139], v226 offset:51200
    v_mfma_f32_16x16x32_bf16 v[24:27], a[36:39], v[56:59], v[24:27]
    v_add_f32 v84, v84, v86
    ds_read_b128 v[48:51], v160 offset:36864
    v_mfma_f32_16x16x32_bf16 v[28:31], a[40:43], v[56:59], v[28:31]
    ds_read_b64_tr_b16 v[140:141], v226 offset:49160
    ds_read_b64_tr_b16 v[142:143], v226 offset:51208
    v_mfma_f32_16x16x32_bf16 v[32:35], a[44:47], v[56:59], v[32:35]
    v_add_f32 v85, v85, v87
    v_add_f32 v80, v80, v84
    v_mfma_f32_16x16x32_bf16 v[36:39], a[36:39], v[60:63], v[36:39]
    s_add_u32 m0, s53, 16384
    ds_read_b128 v[52:55], v160 offset:53248
    v_add_f32 v81, v81, v85
    v_mfma_f32_16x16x32_bf16 v[40:43], a[40:43], v[60:63], v[40:43]
    buffer_load_dwordx4 v250, s[20:23], s51 offen offset:0 lds
    v_mfma_f32_16x16x32_bf16 v[44:47], a[44:47], v[60:63], v[44:47]
    s_waitcnt lgkmcnt(10)
    v_add_f32 v88, v88, v90
    s_add_u32 m0, s53, 16384
    v_mfma_f32_16x16x32_bf16 v[24:27], a[132:135], v[120:123], v[24:27]
    buffer_load_dwordx4 v251, s[20:23], s51 offen offset:1024 lds
    v_mfma_f32_16x16x32_bf16 v[28:31], a[136:139], v[120:123], v[28:31]
    s_add_u32 m0, s53, 16384
    v_add_f32 v89, v89, v91
    v_add_f32 v92, v92, v94
    v_mfma_f32_16x16x32_bf16 v[32:35], a[140:143], v[120:123], v[32:35]
    buffer_load_dwordx4 v252, s[20:23], s51 offen offset:2048 lds
    ds_read_b128 v[56:59], v160 offset:45056
    v_mfma_f32_16x16x32_bf16 v[36:39], a[132:135], v[124:127], v[36:39]
    s_add_u32 m0, s53, 16384
    v_add_f32 v93, v93, v95
    v_add_f32 v88, v88, v92
    v_mfma_f32_16x16x32_bf16 v[40:43], a[136:139], v[124:127], v[40:43]
    buffer_load_dwordx4 v253, s[20:23], s51 offen offset:3072 lds
    ds_read_b128 v[60:63], v160 offset:61440
    v_mfma_f32_16x16x32_bf16 v[44:47], a[140:143], v[124:127], v[44:47]
    s_waitcnt lgkmcnt(2)
    v_add_f32 v89, v89, v93
    s_add_u32 s51, s51, 32768
    v_mfma_f32_16x16x32_bf16 v[24:27], a[48:51], v[48:51], v[24:27]
    v_permlane32_swap_b32 v80, v88
    v_mfma_f32_16x16x32_bf16 v[28:31], a[52:55], v[48:51], v[28:31]
    v_permlane32_swap_b32 v81, v89
    v_mfma_f32_16x16x32_bf16 v[32:35], a[56:59], v[48:51], v[32:35]
    ds_read_b128 v[120:123], v160 offset:37888
    ds_read_b64_tr_b16 v[144:145], v225 offset:32768
    v_mfma_f32_16x16x32_bf16 v[36:39], a[48:51], v[52:55], v[36:39]
    ds_read_b64_tr_b16 v[146:147], v225 offset:34816
    v_add_f32 v80, v80, v88
    v_mfma_f32_16x16x32_bf16 v[40:43], a[52:55], v[52:55], v[40:43]
    ds_read_b64_tr_b16 v[148:149], v225 offset:32776
    v_add_f32 v81, v81, v89
    ds_read_b128 v[124:127], v160 offset:54272
    v_mfma_f32_16x16x32_bf16 v[44:47], a[56:59], v[52:55], v[44:47]
    s_waitcnt lgkmcnt(5)
    ds_read_b64_tr_b16 v[150:151], v225 offset:34824
    ds_read_b64_tr_b16 v[152:153], v226 offset:32768
    v_mfma_f32_16x16x32_bf16 v[24:27], a[144:147], v[56:59], v[24:27]
    buffer_load_dword v239, v228, s[32:35], s59 offen offset:768 sc1
    v_mfma_f32_16x16x32_bf16 v[28:31], a[148:151], v[56:59], v[28:31]
    v_mov_b32 v88, v80
    ds_read_b64_tr_b16 v[154:155], v226 offset:34816
    ds_read_b64_tr_b16 v[156:157], v226 offset:32776
    v_mfma_f32_16x16x32_bf16 v[32:35], a[152:155], v[56:59], v[32:35]
    v_mov_b32 v89, v81
    ds_read_b64_tr_b16 v[158:159], v226 offset:34824
    ds_read_b128 v[48:51], v160 offset:46080
    v_mfma_f32_16x16x32_bf16 v[36:39], a[144:147], v[60:63], v[36:39]
    s_add_u32 m0, s53, 49152
    v_permlane16_swap_b32 v80, v88
    v_mfma_f32_16x16x32_bf16 v[40:43], a[148:151], v[60:63], v[40:43]
    buffer_load_dwordx4 v250, s[20:23], s51 offen offset:0 lds
    v_permlane16_swap_b32 v81, v89
    ds_read_b128 v[52:55], v160 offset:62464
    v_mfma_f32_16x16x32_bf16 v[44:47], a[152:155], v[60:63], v[44:47]
    s_waitcnt lgkmcnt(7)
    s_add_u32 m0, s53, 49152
    v_add_f32 v80, v80, v88
    v_mfma_f32_16x16x32_bf16 v[24:27], a[60:63], v[120:123], v[24:27]
    buffer_load_dwordx4 v251, s[20:23], s51 offen offset:1024 lds
    v_mfma_f32_16x16x32_bf16 v[28:31], a[64:67], v[120:123], v[28:31]
    s_add_u32 m0, s53, 49152
    v_add_f32 v81, v81, v89
    v_mul_f32 v80, 0x3b000000, v80
    v_mfma_f32_16x16x32_bf16 v[32:35], a[68:71], v[120:123], v[32:35]
    buffer_load_dwordx4 v252, s[20:23], s51 offen offset:2048 lds
    ds_read_b128 v[56:59], v160 offset:38912
    v_mfma_f32_16x16x32_bf16 v[36:39], a[60:63], v[124:127], v[36:39]
    s_add_u32 m0, s53, 49152
    v_mul_f32 v81, 0x3b000000, v81
    v_fma_f32 v81, -v80, v80, v81
    buffer_load_dwordx4 v253, s[20:23], s51 offen offset:3072 lds
    s_cmp_eq_u32 s60, 3
    s_cselect_b32 s57, 0, 32768
    s_add_u32 s51, s51, s57
    v_mfma_f32_16x16x32_bf16 v[40:43], a[64:67], v[124:127], v[40:43]
    s_waitcnt lgkmcnt(3)
    v_max_f32 v81, 0, v81
    ds_read_b128 v[60:63], v160 offset:55296
    v_mfma_f32_16x16x32_bf16 v[44:47], a[68:71], v[124:127], v[44:47]
    s_waitcnt lgkmcnt(2)
    v_add_f32 v81, 0x3727c5ac, v81
    s_add_u32 m0, s53, 32768
    v_mfma_f32_16x16x32_bf16 v[24:27], a[156:159], v[48:51], v[24:27]
    buffer_load_dwordx4 v250, s[20:23], s51 offen offset:0 lds
    buffer_load_dword v240, v228, s[32:35], s59 offen offset:768 sc1
    v_mfma_f32_16x16x32_bf16 v[28:31], a[160:163], v[48:51], v[28:31]
    s_add_u32 m0, s53, 32768
    v_rsq_f32 v81, v81
    v_mfma_f32_16x16x32_bf16 v[32:35], a[164:167], v[48:51], v[32:35]
    v_mul_f32_e64 v80, -v80, v81
    ds_read_b128 v[120:123], v160 offset:47104
    v_mfma_f32_16x16x32_bf16 v[36:39], a[156:159], v[52:55], v[36:39]
    buffer_load_dwordx4 v251, s[20:23], s51 offen offset:1024 lds
    v_mfma_f32_16x16x32_bf16 v[40:43], a[160:163], v[52:55], v[40:43]
    v_mov_b32 v89, v81
    v_mov_b32 v88, v80
    ds_read_b128 v[124:127], v160 offset:63488
    v_mfma_f32_16x16x32_bf16 v[44:47], a[164:167], v[52:55], v[44:47]
    s_waitcnt lgkmcnt(2)
    v_permlane32_swap_b32 v81, v89
    v_mfma_f32_16x16x32_bf16 v[24:27], a[72:75], v[56:59], v[24:27]
    s_add_u32 m0, s53, 32768
    v_permlane32_swap_b32 v80, v88
    v_mfma_f32_16x16x32_bf16 v[28:31], a[76:79], v[56:59], v[28:31]
    buffer_load_dwordx4 v252, s[20:23], s51 offen offset:2048 lds
    v_mfma_f32_16x16x32_bf16 v[32:35], a[80:83], v[56:59], v[32:35]
    ds_read_b128 v[48:51], v160 offset:39936
    v_fma_f32 v96, v80, v162, v174
    v_mfma_f32_16x16x32_bf16 v[36:39], a[72:75], v[60:63], v[36:39]
    s_add_u32 m0, s53, 32768
    v_fma_f32 v97, v80, v163, v175
    v_fma_f32 v98, v80, v164, v176
    v_mfma_f32_16x16x32_bf16 v[40:43], a[76:79], v[60:63], v[40:43]
    ds_read_b128 v[52:55], v160 offset:56320
    v_fma_f32 v99, v80, v165, v177
    v_mfma_f32_16x16x32_bf16 v[44:47], a[80:83], v[60:63], v[44:47]
    s_waitcnt lgkmcnt(2)
    v_fma_f32 v100, v80, v166, v178
    v_fma_f32 v101, v80, v167, v179
    v_mfma_f32_16x16x32_bf16 v[24:27], a[168:171], v[120:123], v[24:27]
    buffer_load_dwordx4 v253, s[20:23], s51 offen offset:3072 lds
    v_mfma_f32_16x16x32_bf16 v[28:31], a[172:175], v[120:123], v[28:31]
    v_fma_f32 v102, v80, v168, v180
    ds_read_b128 v[56:59], v160 offset:48128
    v_mfma_f32_16x16x32_bf16 v[32:35], a[176:179], v[120:123], v[32:35]
    v_fma_f32 v103, v80, v169, v181
    v_fma_f32 v104, v80, v170, v182
    v_mfma_f32_16x16x32_bf16 v[36:39], a[168:171], v[124:127], v[36:39]
    ds_read_b128 v[60:63], v160 offset:64512
    v_fma_f32 v105, v80, v171, v183
    v_mfma_f32_16x16x32_bf16 v[40:43], a[172:175], v[124:127], v[40:43]
    v_fma_f32 v106, v80, v172, v184
    v_fma_f32 v107, v80, v173, v185
    v_mfma_f32_16x16x32_bf16 v[44:47], a[176:179], v[124:127], v[44:47]
    s_waitcnt lgkmcnt(2)
    v_fma_f32 v108, v88, v162, v174
    v_fma_f32 v109, v88, v163, v175
    v_mfma_f32_16x16x32_bf16 v[24:27], a[84:87], v[48:51], v[24:27]
    v_fma_f32 v110, v88, v164, v176
    v_fma_f32 v111, v88, v165, v177
    v_mfma_f32_16x16x32_bf16 v[28:31], a[88:91], v[48:51], v[28:31]
    v_fma_f32 v112, v88, v166, v178
    v_fma_f32 v113, v88, v167, v179
    v_mfma_f32_16x16x32_bf16 v[32:35], a[92:95], v[48:51], v[32:35]
    v_fma_f32 v114, v88, v168, v180
    v_fma_f32 v115, v88, v169, v181
    v_mfma_f32_16x16x32_bf16 v[36:39], a[84:87], v[52:55], v[36:39]
    v_fma_f32 v116, v88, v170, v182
    v_fma_f32 v117, v88, v171, v183
    v_mfma_f32_16x16x32_bf16 v[40:43], a[88:91], v[52:55], v[40:43]
    v_fma_f32 v118, v88, v172, v184
    v_mfma_f32_16x16x32_bf16 v[44:47], a[92:95], v[52:55], v[44:47]
    s_waitcnt lgkmcnt(0)
    v_fma_f32 v119, v88, v173, v185
    v_mfma_f32_16x16x32_bf16 v[24:27], a[180:183], v[56:59], v[24:27]
    v_mfma_f32_16x16x32_bf16 v[28:31], a[184:187], v[56:59], v[28:31]
    v_mfma_f32_16x16x32_bf16 v[32:35], a[188:191], v[56:59], v[32:35]
    v_mfma_f32_16x16x32_bf16 v[36:39], a[180:183], v[60:63], v[36:39]
    v_mfma_f32_16x16x32_bf16 v[40:43], a[184:187], v[60:63], v[40:43]
    v_mfma_f32_16x16x32_bf16 v[44:47], a[188:191], v[60:63], v[44:47]
    s_nop 2
    v_pk_fma_f32 v[24:25], v[24:25], v[80:81], v[96:97] op_sel:[0,1,0] op_sel_hi:[1,1,1]
    s_waitcnt vmcnt(9)
    v_cmp_ne_u32 vcc, s96, v239
    s_nop 1
    s_cbranch_vccz L_WD_47
    s_waitcnt vmcnt(3)
    v_cmp_ne_u32 vcc, s96, v240
    s_nop 3
    s_cbranch_vccz L_WD_47
    s_mov_b32 s40, 20000
L_WF_49:
    v_xor_b32 v239, s96, v239
    v_cmp_lt_u32 vcc, 15, v239
    s_nop 3
    s_cbranch_vccz L_WK_50
    buffer_load_dword v239, v228, s[32:35], s59 offen offset:768 sc1
    s_waitcnt vmcnt(0)
    s_sub_u32 s40, s40, 1
    s_cbranch_scc0 L_WF_49
L_WK_50:
L_WD_47:
    v_pk_fma_f32 v[26:27], v[26:27], v[80:81], v[98:99] op_sel:[0,1,0] op_sel_hi:[1,1,1]
    v_cvt_pk_bf16_f32 v96, v24, v25
    v_cvt_pk_bf16_f32 v97, v26, v27
    v_pk_fma_f32 v[36:37], v[36:37], v[88:89], v[108:109] op_sel:[0,1,0] op_sel_hi:[1,1,1]
    v_pk_fma_f32 v[38:39], v[38:39], v[88:89], v[110:111] op_sel:[0,1,0] op_sel_hi:[1,1,1]
    buffer_load_dwordx4 a[96:99], v255, s[32:35], s72 offen offset:0 sc1
    v_cvt_pk_bf16_f32 v98, v36, v37
    v_cvt_pk_bf16_f32 v99, v38, v39
    v_pk_max_i16 v96, v96, 0
    v_pk_max_i16 v98, v98, 0
    v_pk_max_i16 v97, v97, 0
    v_pk_max_i16 v99, v99, 0
    buffer_load_dwordx4 a[100:103], v255, s[32:35], s72 offen offset:1024 sc1
    v_permlane16_swap_b32 v96, v98
    v_permlane16_swap_b32 v97, v99
    buffer_store_dwordx4 v[96:99], v232, s[32:35], s49 offen offset:0 sc1
    v_pk_fma_f32 v[28:29], v[28:29], v[80:81], v[100:101] op_sel:[0,1,0] op_sel_hi:[1,1,1]
    v_pk_fma_f32 v[30:31], v[30:31], v[80:81], v[102:103] op_sel:[0,1,0] op_sel_hi:[1,1,1]
    buffer_load_dwordx4 a[104:107], v255, s[32:35], s72 offen offset:2048 sc1
    v_cvt_pk_bf16_f32 v100, v28, v29
    v_cvt_pk_bf16_f32 v101, v30, v31
    v_pk_fma_f32 v[40:41], v[40:41], v[88:89], v[112:113] op_sel:[0,1,0] op_sel_hi:[1,1,1]
    v_pk_fma_f32 v[42:43], v[42:43], v[88:89], v[114:115] op_sel:[0,1,0] op_sel_hi:[1,1,1]
    v_cvt_pk_bf16_f32 v102, v40, v41
    v_cvt_pk_bf16_f32 v103, v42, v43
    buffer_load_dwordx4 a[108:111], v255, s[32:35], s72 offen offset:3072 sc1
    v_pk_max_i16 v100, v100, 0
    v_pk_max_i16 v102, v102, 0
    v_pk_max_i16 v101, v101, 0
    v_pk_max_i16 v103, v103, 0
    v_permlane16_swap_b32 v100, v102
    s_nop 0
    v_permlane16_swap_b32 v101, v103
    s_add_u32 s72, s72, 4096
    buffer_load_dwordx4 a[112:115], v255, s[32:35], s72 offen offset:0 sc1
    buffer_store_dwordx4 v[100:103], v232, s[32:35], s48 offen offset:512 sc1
    v_pk_fma_f32 v[32:33], v[32:33], v[80:81], v[104:105] op_sel:[0,1,0] op_sel_hi:[1,1,1]
    v_pk_fma_f32 v[34:35], v[34:35], v[80:81], v[106:107] op_sel:[0,1,0] op_sel_hi:[1,1,1]
    v_cvt_pk_bf16_f32 v104, v32, v33
    v_cvt_pk_bf16_f32 v105, v34, v35
    buffer_load_dwordx4 a[116:119], v255, s[32:35], s72 offen offset:1024 sc1
    v_pk_fma_f32 v[44:45], v[44:45], v[88:89], v[116:117] op_sel:[0,1,0] op_sel_hi:[1,1,1]
    v_pk_fma_f32 v[46:47], v[46:47], v[88:89], v[118:119] op_sel:[0,1,0] op_sel_hi:[1,1,1]
    v_cvt_pk_bf16_f32 v106, v44, v45
    v_cvt_pk_bf16_f32 v107, v46, v47
    v_pk_max_i16 v104, v104, 0
    v_pk_max_i16 v106, v106, 0
    buffer_load_dwordx4 a[120:123], v255, s[32:35], s73 offen offset:0 sc1
    v_pk_max_i16 v105, v105, 0
    v_pk_max_i16 v107, v107, 0
    v_permlane16_swap_b32 v104, v106
    s_nop 0
    v_permlane16_swap_b32 v105, v107
    buffer_store_dwordx4 v[104:107], v232, s[32:35], s48 offen offset:1024 sc1
    v_lshlrev_b32 v186, 16, v202
    buffer_load_dwordx4 a[124:127], v255, s[32:35], s73 offen offset:1024 sc1
    v_and_b32 v187, 0xffff0000, v202
    v_lshlrev_b32 v188, 16, v203
    v_and_b32 v189, 0xffff0000, v203
    v_lshlrev_b32 v190, 16, v204
    v_and_b32 v191, 0xffff0000, v204
    v_lshlrev_b32 v192, 16, v205
    v_and_b32 v193, 0xffff0000, v205
    v_lshlrev_b32 v112, 16, v206
    v_and_b32 v113, 0xffff0000, v206
    v_lshlrev_b32 v114, 16, v207
    v_and_b32 v115, 0xffff0000, v207
    v_lshlrev_b32 v116, 16, v208
    v_and_b32 v117, 0xffff0000, v208
    v_lshlrev_b32 v118, 16, v209
    v_and_b32 v119, 0xffff0000, v209
    v_lshlrev_b32 v120, 16, v210
    v_and_b32 v121, 0xffff0000, v210
    v_lshlrev_b32 v122, 16, v211
    v_and_b32 v123, 0xffff0000, v211
    v_lshlrev_b32 v124, 16, v212
    v_and_b32 v125, 0xffff0000, v212
    v_lshlrev_b32 v126, 16, v213
    v_and_b32 v127, 0xffff0000, v213
    s_waitcnt vmcnt(10)
    v_mfma_f32_16x16x32_bf16 v[0:3], a[192:195], a[96:99], 0
    buffer_load_dwordx4 a[128:131], v255, s[32:35], s73 offen offset:2048 sc1
    v_mfma_f32_16x16x32_bf16 v[4:7], a[196:199], a[96:99], 0
    v_add_u32 v220, 73728, v225
    v_add_u32 v221, 73728, v226
    v_mfma_f32_16x16x32_bf16 v[8:11], a[200:203], a[96:99], 0
    ds_read_b64_tr_b16 a[0:1], v220 offset:0
    ds_read_b64_tr_b16 a[2:3], v220 offset:2048
    v_mfma_f32_16x16x32_bf16 v[12:15], a[204:207], a[96:99], 0
    ds_read_b64_tr_b16 a[4:5], v220 offset:8
    ds_read_b64_tr_b16 a[6:7], v220 offset:2056
    s_waitcnt vmcnt(10)
    v_mfma_f32_16x16x32_bf16 v[0:3], a[208:211], a[100:103], v[0:3]
    buffer_load_dwordx4 a[132:135], v255, s[32:35], s73 offen offset:3072 sc1
    v_mfma_f32_16x16x32_bf16 v[4:7], a[212:215], a[100:103], v[4:7]
    s_add_u32 s73, s73, 4096
    ds_read_b64_tr_b16 a[8:9], v221 offset:0
    ds_read_b64_tr_b16 a[10:11], v221 offset:2048
    v_mfma_f32_16x16x32_bf16 v[8:11], a[216:219], a[100:103], v[8:11]
    ds_read_b64_tr_b16 a[12:13], v221 offset:8
    v_mfma_f32_16x16x32_bf16 v[12:15], a[220:223], a[100:103], v[12:15]
    ds_read_b64_tr_b16 a[14:15], v221 offset:2056
    s_waitcnt vmcnt(9)
    v_mfma_f32_16x16x32_bf16 v[0:3], a[224:227], a[104:107], v[0:3]
    v_mfma_f32_16x16x32_bf16 v[4:7], a[228:231], a[104:107], v[4:7]
    buffer_load_dwordx4 a[136:139], v255, s[32:35], s73 offen offset:0 sc1
    v_mfma_f32_16x16x32_bf16 v[8:11], a[232:235], a[104:107], v[8:11]
    ds_read_b64_tr_b16 a[16:17], v225 offset:0
    v_mfma_f32_16x16x32_bf16 v[12:15], a[236:239], a[104:107], v[12:15]
    ds_read_b64_tr_b16 a[18:19], v225 offset:2048
    s_waitcnt vmcnt(9)
    v_mfma_f32_16x16x32_bf16 v[0:3], a[240:243], a[108:111], v[0:3]
    ds_read_b64_tr_b16 a[20:21], v225 offset:8
    v_mfma_f32_16x16x32_bf16 v[4:7], a[244:247], a[108:111], v[4:7]
    buffer_load_dwordx4 a[140:143], v255, s[32:35], s73 offen offset:1024 sc1
    v_mfma_f32_16x16x32_bf16 v[8:11], a[248:251], a[108:111], v[8:11]
    ds_read_b64_tr_b16 a[22:23], v225 offset:2056
    ds_read_b64_tr_b16 a[24:25], v226 offset:0
    v_mfma_f32_16x16x32_bf16 v[12:15], a[252:255], a[108:111], v[12:15]
    ds_read_b64_tr_b16 a[26:27], v226 offset:2048
    s_waitcnt vmcnt(9)
    v_mfma_f32_16x16x32_bf16 v[0:3], v[128:131], a[112:115], v[0:3]
    v_mfma_f32_16x16x32_bf16 v[4:7], v[132:135], a[112:115], v[4:7]
    buffer_load_dwordx4 a[144:147], v255, s[32:35], s72 offen offset:2048 sc1
    v_mfma_f32_16x16x32_bf16 v[8:11], v[136:139], a[112:115], v[8:11]
    ds_read_b64_tr_b16 a[28:29], v226 offset:8
    ds_read_b64_tr_b16 a[30:31], v226 offset:2056
    v_mfma_f32_16x16x32_bf16 v[12:15], v[140:143], a[112:115], v[12:15]
    s_waitcnt vmcnt(8)
    v_mfma_f32_16x16x32_bf16 v[0:3], v[144:147], a[116:119], v[0:3]
    ds_read_b64_tr_b16 a[32:33], v225 offset:16384
    v_mfma_f32_16x16x32_bf16 v[4:7], v[148:151], a[116:119], v[4:7]
    buffer_load_dwordx4 a[148:151], v255, s[32:35], s72 offen offset:3072 sc1
    v_mfma_f32_16x16x32_bf16 v[8:11], v[152:155], a[116:119], v[8:11]
    s_waitcnt vmcnt(7)
    s_mov_b64 exec, 2
    s_cmp_lg_u32 s97, 0
    s_cbranch_scc1 L_XS_51
    buffer_store_dword v254, v255, s[32:35], s58 offen offset:880
L_XD_52:
    s_mov_b64 exec, -1
    v_mfma_f32_16x16x32_bf16 v[12:15], v[156:159], a[116:119], v[12:15]
    s_add_u32 s72, s72, 4096
    ds_read_b64_tr_b16 a[34:35], v225 offset:18432
    ds_read_b64_tr_b16 a[36:37], v225 offset:16392
    v_mfma_f32_16x16x32_bf16 v[16:19], a[192:195], a[120:123], 0
    ds_read_b64_tr_b16 a[38:39], v225 offset:18440
    v_mfma_f32_16x16x32_bf16 v[20:23], a[196:199], a[120:123], 0
    ds_read_b64_tr_b16 a[40:41], v226 offset:16384
    v_mfma_f32_16x16x32_bf16 v[24:27], a[200:203], a[120:123], 0
    v_mfma_f32_16x16x32_bf16 v[28:31], a[204:207], a[120:123], 0
    buffer_load_dwordx4 a[152:155], v255, s[32:35], s72 offen offset:0 sc1
    s_waitcnt vmcnt(8)
    v_mfma_f32_16x16x32_bf16 v[16:19], a[208:211], a[124:127], v[16:19]
    ds_read_b64_tr_b16 a[42:43], v226 offset:18432
    ds_read_b64_tr_b16 a[44:45], v226 offset:16392
    v_mfma_f32_16x16x32_bf16 v[20:23], a[212:215], a[124:127], v[20:23]
    ds_read_b64_tr_b16 a[46:47], v226 offset:18440
    v_mfma_f32_16x16x32_bf16 v[24:27], a[216:219], a[124:127], v[24:27]
    v_mfma_f32_16x16x32_bf16 v[28:31], a[220:223], a[124:127], v[28:31]
    buffer_load_dwordx4 a[156:159], v255, s[32:35], s72 offen offset:1024 sc1
    s_waitcnt vmcnt(8)
    v_mfma_f32_16x16x32_bf16 v[16:19], a[224:227], a[128:131], v[16:19]
    s_add_u32 s72, s72, s76
    ds_read_b64_tr_b16 a[48:49], v225 offset:49152
    v_mfma_f32_16x16x32_bf16 v[20:23], a[228:231], a[128:131], v[20:23]
    ds_read_b64_tr_b16 a[50:51], v225 offset:51200
    v_mfma_f32_16x16x32_bf16 v[24:27], a[232:235], a[128:131], v[24:27]
    ds_read_b64_tr_b16 a[52:53], v225 offset:49160
    v_mfma_f32_16x16x32_bf16 v[28:31], a[236:239], a[128:131], v[28:31]
    ds_read_b64_tr_b16 a[54:55], v225 offset:51208
    s_waitcnt vmcnt(7)
    v_mfma_f32_16x16x32_bf16 v[16:19], a[240:243], a[132:135], v[16:19]
    buffer_load_dwordx4 a[160:163], v255, s[32:35], s72 offen offset:2048 sc1
    v_mfma_f32_16x16x32_bf16 v[20:23], a[244:247], a[132:135], v[20:23]
    ds_read_b64_tr_b16 a[56:57], v226 offset:49152
    v_mfma_f32_16x16x32_bf16 v[24:27], a[248:251], a[132:135], v[24:27]
    ds_read_b64_tr_b16 a[58:59], v226 offset:51200
    v_mfma_f32_16x16x32_bf16 v[28:31], a[252:255], a[132:135], v[28:31]
    ds_read_b64_tr_b16 a[60:61], v226 offset:49160
    s_waitcnt vmcnt(7)
    v_mfma_f32_16x16x32_bf16 v[16:19], v[128:131], a[136:139], v[16:19]
    buffer_load_dwordx4 a[164:167], v255, s[32:35], s73 offen offset:2048 sc1
    v_mfma_f32_16x16x32_bf16 v[20:23], v[132:135], a[136:139], v[20:23]
    ds_read_b64_tr_b16 a[62:63], v226 offset:51208
    v_mfma_f32_16x16x32_bf16 v[24:27], v[136:139], a[136:139], v[24:27]
    buffer_load_dword v239, v228, s[32:35], s59 offen offset:896 sc1
    v_mfma_f32_16x16x32_bf16 v[28:31], v[140:143], a[136:139], v[28:31]
    ds_read_b64_tr_b16 a[64:65], v225 offset:32768
    s_waitcnt vmcnt(8)
    v_mfma_f32_16x16x32_bf16 v[16:19], v[144:147], a[140:143], v[16:19]
    buffer_load_dwordx4 a[168:171], v255, s[32:35], s73 offen offset:3072 sc1
    v_mfma_f32_16x16x32_bf16 v[20:23], v[148:151], a[140:143], v[20:23]
    s_add_u32 s73, s73, 4096
    ds_read_b64_tr_b16 a[66:67], v225 offset:34816
    ds_read_b64_tr_b16 a[68:69], v225 offset:32776
    v_mfma_f32_16x16x32_bf16 v[24:27], v[152:155], a[140:143], v[24:27]
    ds_read_b64_tr_b16 a[70:71], v225 offset:34824
    v_mfma_f32_16x16x32_bf16 v[28:31], v[156:159], a[140:143], v[28:31]
    s_waitcnt vmcnt(8) lgkmcnt(15)
    v_mfma_f32_16x16x32_bf16 v[0:3], a[0:3], a[144:147], v[0:3]
    ds_read_b64_tr_b16 a[72:73], v226 offset:32768
    s_waitcnt lgkmcnt(15)
    v_mfma_f32_16x16x32_bf16 v[4:7], a[4:7], a[144:147], v[4:7]
    ds_read_b64_tr_b16 a[74:75], v226 offset:34816
    s_waitcnt lgkmcnt(15)
    v_mfma_f32_16x16x32_bf16 v[8:11], a[8:11], a[144:147], v[8:11]
    s_branch L_O5
.p2alignl 12, 0xbf810000
L_HN11:
    s_branch L_BN1
L_HU11:
    s_branch L_BU1
L_HL11:
    s_branch L_BL1
L_O5:
    buffer_load_dword v240, v228, s[32:35], s59 offen offset:896 sc1
    s_waitcnt lgkmcnt(15)
    v_mfma_f32_16x16x32_bf16 v[12:15], a[12:15], a[144:147], v[12:15]
    buffer_load_dwordx4 a[172:175], v255, s[32:35], s73 offen offset:0 sc1
    s_waitcnt vmcnt(9) lgkmcnt(15)
    v_mfma_f32_16x16x32_bf16 v[0:3], a[16:19], a[148:151], v[0:3]
    ds_read_b64_tr_b16 a[76:77], v226 offset:32776
    ds_read_b64_tr_b16 a[78:79], v226 offset:34824
    s_waitcnt lgkmcnt(15)
    v_mfma_f32_16x16x32_bf16 v[4:7], a[20:23], a[148:151], v[4:7]
    s_waitcnt lgkmcnt(15)
    v_mfma_f32_16x16x32_bf16 v[8:11], a[24:27], a[148:151], v[8:11]
    buffer_load_dwordx4 a[176:179], v255, s[32:35], s73 offen offset:1024 sc1
    s_waitcnt lgkmcnt(15)
    v_mfma_f32_16x16x32_bf16 v[12:15], a[28:31], a[148:151], v[12:15]
    s_add_u32 s73, s73, s76
    s_waitcnt vmcnt(8) lgkmcnt(15)
    v_mfma_f32_16x16x32_bf16 v[0:3], a[32:35], a[152:155], v[0:3]
    s_waitcnt lgkmcnt(15)
    v_mfma_f32_16x16x32_bf16 v[4:7], a[36:39], a[152:155], v[4:7]
    s_waitcnt lgkmcnt(15)
    v_mfma_f32_16x16x32_bf16 v[8:11], a[40:43], a[152:155], v[8:11]
    buffer_load_dword v246, v228, s[32:35], s59 offen offset:896 sc1
    s_waitcnt lgkmcnt(15)
    v_mfma_f32_16x16x32_bf16 v[12:15], a[44:47], a[152:155], v[12:15]
    buffer_load_dwordx4 a[180:183], v255, s[32:35], s73 offen offset:2048 sc1
    s_waitcnt vmcnt(9) lgkmcnt(14)
    v_mfma_f32_16x16x32_bf16 v[0:3], a[48:51], a[156:159], v[0:3]
    s_waitcnt lgkmcnt(12)
    v_mfma_f32_16x16x32_bf16 v[4:7], a[52:55], a[156:159], v[4:7]
    s_waitcnt lgkmcnt(10)
    v_mfma_f32_16x16x32_bf16 v[8:11], a[56:59], a[156:159], v[8:11]
    s_waitcnt lgkmcnt(8)
    v_mfma_f32_16x16x32_bf16 v[12:15], a[60:63], a[156:159], v[12:15]
    s_waitcnt vmcnt(8) lgkmcnt(6)
    v_mfma_f32_16x16x32_bf16 v[0:3], a[64:67], a[160:163], v[0:3]
    s_waitcnt lgkmcnt(4)
    v_mfma_f32_16x16x32_bf16 v[4:7], a[68:71], a[160:163], v[4:7]
    s_waitcnt lgkmcnt(2)
    v_mfma_f32_16x16x32_bf16 v[8:11], a[72:75], a[160:163], v[8:11]
    s_waitcnt lgkmcnt(0)
    v_mfma_f32_16x16x32_bf16 v[12:15], a[76:79], a[160:163], v[12:15]
    s_waitcnt vmcnt(7)
    v_mfma_f32_16x16x32_bf16 v[16:19], a[0:3], a[164:167], v[16:19]
    v_mfma_f32_16x16x32_bf16 v[20:23], a[4:7], a[164:167], v[20:23]
    s_waitcnt vmcnt(6)
    v_cmp_ne_u32 vcc, s96, v239
    s_nop 1
    s_cbranch_vccz L_WD_53
    s_waitcnt vmcnt(4)
    v_cmp_ne_u32 vcc, s96, v240
    s_nop 3
    s_cbranch_vccz L_WD_53
    s_waitcnt vmcnt(1)
    v_cmp_ne_u32 vcc, s96, v246
    s_nop 3
    s_cbranch_vccz L_WD_53
    s_mov_b32 s40, 20000
L_WF_55:
    v_xor_b32 v239, s96, v239
    v_cmp_lt_u32 vcc, 15, v239
    s_nop 3
    s_cbranch_vccz L_WK_56
    buffer_load_dword v239, v228, s[32:35], s59 offen offset:896 sc1
    s_waitcnt vmcnt(0)
    s_sub_u32 s40, s40, 1
    s_cbranch_scc0 L_WF_55
L_WK_56:
L_WD_53:
    v_mfma_f32_16x16x32_bf16 v[24:27], a[8:11], a[164:167], v[24:27]
    buffer_load_dwordx4 a[184:187], v255, s[32:35], s74 offen offset:0 sc1
    v_mfma_f32_16x16x32_bf16 v[28:31], a[12:15], a[164:167], v[28:31]
    buffer_load_dwordx4 a[188:191], v255, s[32:35], s74 offen offset:1024 sc1
    s_waitcnt vmcnt(7)
    v_mfma_f32_16x16x32_bf16 v[16:19], a[16:19], a[168:171], v[16:19]
    ds_write_b128 v214, v[0:3] offset:0
    v_mfma_f32_16x16x32_bf16 v[20:23], a[20:23], a[168:171], v[20:23]
    v_mfma_f32_16x16x32_bf16 v[24:27], a[24:27], a[168:171], v[24:27]
    buffer_load_dwordx4 a[80:83], v255, s[32:35], s74 offen offset:2048 sc1
    v_mfma_f32_16x16x32_bf16 v[28:31], a[28:31], a[168:171], v[28:31]
    ds_write_b128 v214, v[4:7] offset:1024
    s_waitcnt vmcnt(6)
    v_mfma_f32_16x16x32_bf16 v[16:19], a[32:35], a[172:175], v[16:19]
    v_mfma_f32_16x16x32_bf16 v[20:23], a[36:39], a[172:175], v[20:23]
    buffer_load_dwordx4 a[84:87], v255, s[32:35], s74 offen offset:3072 sc1
    v_mfma_f32_16x16x32_bf16 v[24:27], a[40:43], a[172:175], v[24:27]
    ds_write_b128 v215, v[8:11] offset:2048
    v_mfma_f32_16x16x32_bf16 v[28:31], a[44:47], a[172:175], v[28:31]
    s_add_u32 s74, s74, 4096
    s_waitcnt vmcnt(6)
    v_mfma_f32_16x16x32_bf16 v[16:19], a[48:51], a[176:179], v[16:19]
    v_mfma_f32_16x16x32_bf16 v[20:23], a[52:55], a[176:179], v[20:23]
    buffer_load_dwordx4 a[88:91], v255, s[32:35], s74 offen offset:0 sc1
    v_mfma_f32_16x16x32_bf16 v[24:27], a[56:59], a[176:179], v[24:27]
    ds_write_b128 v215, v[12:15] offset:3072
    v_mfma_f32_16x16x32_bf16 v[28:31], a[60:63], a[176:179], v[28:31]
    s_waitcnt vmcnt(5)
    v_mfma_f32_16x16x32_bf16 v[16:19], a[64:67], a[180:183], v[16:19]
    buffer_load_dwordx4 a[92:95], v255, s[32:35], s74 offen offset:1024 sc1
    v_mfma_f32_16x16x32_bf16 v[20:23], a[68:71], a[180:183], v[20:23]
    v_mfma_f32_16x16x32_bf16 v[24:27], a[72:75], a[180:183], v[24:27]
    v_mfma_f32_16x16x32_bf16 v[28:31], a[76:79], a[180:183], v[28:31]
    s_nop 3
    ds_write_b128 v216, v[16:19] offset:4096
    buffer_load_dwordx4 a[96:99], v255, s[32:35], s74 offen offset:2048 sc1
    ds_write_b128 v216, v[20:23] offset:5120
    s_waitcnt lgkmcnt(0)
    s_barrier
    ds_read_b128 v[64:67], v217 offset:0
    buffer_load_dwordx4 a[100:103], v255, s[32:35], s74 offen offset:3072 sc1
    ds_read_b128 v[68:71], v217 offset:1024
    ds_read_b128 v[72:75], v217 offset:2048
    ds_read_b128 v[76:79], v217 offset:3072
    s_add_u32 s74, s74, 4096
    buffer_load_dwordx4 a[104:107], v255, s[32:35], s74 offen offset:0 sc1
    ds_read_b128 v[80:83], v217 offset:4096
    ds_read_b128 v[84:87], v217 offset:5120
    s_waitcnt vmcnt(8)
    v_mfma_f32_16x16x32_bf16 v[32:35], a[192:195], a[184:187], 0
    buffer_load_dwordx4 a[108:111], v255, s[32:35], s74 offen offset:1024 sc1
    v_mfma_f32_16x16x32_bf16 v[36:39], a[196:199], a[184:187], 0
    s_add_u32 s74, s74, s76
    s_waitcnt lgkmcnt(3)
    v_add_f32 v64, v64, v72
    v_add_f32 v65, v65, v73
    v_mfma_f32_16x16x32_bf16 v[40:43], a[200:203], a[184:187], 0
    v_add_f32 v66, v66, v74
    v_add_f32 v67, v67, v75
    v_mfma_f32_16x16x32_bf16 v[44:47], a[204:207], a[184:187], 0
    buffer_load_dwordx4 a[112:115], v255, s[32:35], s74 offen offset:2048 sc1
    s_waitcnt vmcnt(9)
    v_mfma_f32_16x16x32_bf16 v[32:35], a[208:211], a[188:191], v[32:35]
    s_waitcnt lgkmcnt(2)
    v_add_f32 v68, v68, v76
    v_add_f32 v69, v69, v77
    v_mfma_f32_16x16x32_bf16 v[36:39], a[212:215], a[188:191], v[36:39]
    v_add_f32 v70, v70, v78
    v_add_f32 v71, v71, v79
    v_mfma_f32_16x16x32_bf16 v[40:43], a[216:219], a[188:191], v[40:43]
    buffer_load_dwordx4 a[116:119], v255, s[32:35], s75 offen offset:0 sc1
    v_mfma_f32_16x16x32_bf16 v[44:47], a[220:223], a[188:191], v[44:47]
    s_waitcnt lgkmcnt(1)
    v_add_f32 v64, v64, v80
    v_add_f32 v65, v65, v81
    s_waitcnt vmcnt(9)
    v_mfma_f32_16x16x32_bf16 v[32:35], a[224:227], a[80:83], v[32:35]
    v_add_f32 v66, v66, v82
    v_add_f32 v67, v67, v83
    v_mfma_f32_16x16x32_bf16 v[36:39], a[228:231], a[80:83], v[36:39]
    buffer_load_dwordx4 a[120:123], v255, s[32:35], s75 offen offset:1024 sc1
    v_mfma_f32_16x16x32_bf16 v[40:43], a[232:235], a[80:83], v[40:43]
    s_waitcnt lgkmcnt(0)
    v_add_f32 v68, v68, v84
    v_add_f32 v69, v69, v85
    v_mfma_f32_16x16x32_bf16 v[44:47], a[236:239], a[80:83], v[44:47]
    v_add_f32 v70, v70, v86
    v_add_f32 v71, v71, v87
    s_waitcnt vmcnt(9)
    v_mfma_f32_16x16x32_bf16 v[32:35], a[240:243], a[84:87], v[32:35]
    buffer_load_dwordx4 a[124:127], v255, s[32:35], s75 offen offset:2048 sc1
    v_mfma_f32_16x16x32_bf16 v[36:39], a[244:247], a[84:87], v[36:39]
    v_fma_f32 v112, v64, v186, v112
    v_fma_f32 v113, v65, v187, v113
    v_mfma_f32_16x16x32_bf16 v[40:43], a[248:251], a[84:87], v[40:43]
    buffer_load_dwordx4 a[128:131], v255, s[32:35], s75 offen offset:3072 sc1
    v_mfma_f32_16x16x32_bf16 v[44:47], a[252:255], a[84:87], v[44:47]
    s_add_u32 s75, s75, 4096
    v_fma_f32 v114, v66, v188, v114
    v_fma_f32 v115, v67, v189, v115
    s_waitcnt vmcnt(10)
    v_mfma_f32_16x16x32_bf16 v[32:35], v[128:131], a[88:91], v[32:35]
    v_fma_f32 v116, v68, v190, v116
    v_mfma_f32_16x16x32_bf16 v[36:39], v[132:135], a[88:91], v[36:39]
    v_fma_f32 v117, v69, v191, v117
    v_mfma_f32_16x16x32_bf16 v[40:43], v[136:139], a[88:91], v[40:43]
    buffer_load_dwordx4 a[132:135], v255, s[32:35], s75 offen offset:0 sc1
    v_mfma_f32_16x16x32_bf16 v[44:47], v[140:143], a[88:91], v[44:47]
    v_fma_f32 v118, v70, v192, v118
    v_fma_f32 v119, v71, v193, v119
    s_waitcnt vmcnt(10)
    v_mfma_f32_16x16x32_bf16 v[32:35], v[144:147], a[92:95], v[32:35]
    v_fma_f32 v24, v24, v186, v112
    v_mfma_f32_16x16x32_bf16 v[36:39], v[148:151], a[92:95], v[36:39]
    buffer_load_dwordx4 a[136:139], v255, s[32:35], s75 offen offset:1024 sc1
    v_mfma_f32_16x16x32_bf16 v[40:43], v[152:155], a[92:95], v[40:43]
    v_fma_f32 v25, v25, v187, v113
    v_fma_f32 v26, v26, v188, v114
    v_mfma_f32_16x16x32_bf16 v[44:47], v[156:159], a[92:95], v[44:47]
    v_fma_f32 v27, v27, v189, v115
    s_waitcnt vmcnt(10)
    v_mfma_f32_16x16x32_bf16 v[32:35], a[0:3], a[96:99], v[32:35]
    buffer_load_dwordx4 a[140:143], v255, s[32:35], s75 offen offset:2048 sc1
    v_mfma_f32_16x16x32_bf16 v[36:39], a[4:7], a[96:99], v[36:39]
    v_fma_f32 v28, v28, v190, v116
    v_fma_f32 v29, v29, v191, v117
    v_mfma_f32_16x16x32_bf16 v[40:43], a[8:11], a[96:99], v[40:43]
    buffer_load_dwordx4 a[144:147], v255, s[32:35], s75 offen offset:3072 sc1
    v_mfma_f32_16x16x32_bf16 v[44:47], a[12:15], a[96:99], v[44:47]
    s_add_u32 s75, s75, 4096
    v_fma_f32 v30, v30, v192, v118
    v_fma_f32 v31, v31, v193, v119
    s_waitcnt vmcnt(11)
    v_mfma_f32_16x16x32_bf16 v[32:35], a[16:19], a[100:103], v[32:35]
    v_cvt_pk_bf16_f32 v64, v24, v25
    v_mfma_f32_16x16x32_bf16 v[36:39], a[20:23], a[100:103], v[36:39]
    v_cvt_pk_bf16_f32 v65, v26, v27
    v_mfma_f32_16x16x32_bf16 v[40:43], a[24:27], a[100:103], v[40:43]
    buffer_load_dwordx4 a[148:151], v255, s[32:35], s75 offen offset:0 sc1
    v_mfma_f32_16x16x32_bf16 v[44:47], a[28:31], a[100:103], v[44:47]
    v_cvt_pk_bf16_f32 v66, v28, v29
    v_cvt_pk_bf16_f32 v67, v30, v31
    s_waitcnt vmcnt(11)
    v_mfma_f32_16x16x32_bf16 v[32:35], a[32:35], a[104:107], v[32:35]
    v_mfma_f32_16x16x32_bf16 v[36:39], a[36:39], a[104:107], v[36:39]
    buffer_load_dwordx4 a[152:155], v255, s[32:35], s75 offen offset:1024 sc1
    v_mfma_f32_16x16x32_bf16 v[40:43], a[40:43], a[104:107], v[40:43]
    s_add_u32 s75, s75, s76
    v_mfma_f32_16x16x32_bf16 v[44:47], a[44:47], a[104:107], v[44:47]
    s_waitcnt vmcnt(11)
    v_mfma_f32_16x16x32_bf16 v[32:35], a[48:51], a[108:111], v[32:35]
    v_mfma_f32_16x16x32_bf16 v[36:39], a[52:55], a[108:111], v[36:39]
    buffer_load_dwordx4 a[156:159], v255, s[32:35], s75 offen offset:2048 sc1
    v_mfma_f32_16x16x32_bf16 v[40:43], a[56:59], a[108:111], v[40:43]
    buffer_store_dwordx4 v[64:67], v234, s[28:31], s42 offen
    v_mfma_f32_16x16x32_bf16 v[44:47], a[60:63], a[108:111], v[44:47]
    s_cmp_eq_u32 s79, 1021
    s_cbranch_scc1 L_SD_41
L_SX_42:
    s_waitcnt vmcnt(12)
    v_mfma_f32_16x16x32_bf16 v[32:35], a[64:67], a[112:115], v[32:35]
    v_mfma_f32_16x16x32_bf16 v[36:39], a[68:71], a[112:115], v[36:39]
    v_mfma_f32_16x16x32_bf16 v[40:43], a[72:75], a[112:115], v[40:43]
    v_mfma_f32_16x16x32_bf16 v[44:47], a[76:79], a[112:115], v[44:47]
    s_waitcnt vmcnt(11)
    v_mfma_f32_16x16x32_bf16 v[48:51], a[192:195], a[116:119], 0
    v_mfma_f32_16x16x32_bf16 v[52:55], a[196:199], a[116:119], 0
    v_mfma_f32_16x16x32_bf16 v[56:59], a[200:203], a[116:119], 0
    v_mfma_f32_16x16x32_bf16 v[60:63], a[204:207], a[116:119], 0
    ds_write_b128 v214, v[32:35] offset:32768
    s_waitcnt vmcnt(10)
    v_mfma_f32_16x16x32_bf16 v[48:51], a[208:211], a[120:123], v[48:51]
    v_mfma_f32_16x16x32_bf16 v[52:55], a[212:215], a[120:123], v[52:55]
    ds_write_b128 v214, v[36:39] offset:33792
    v_mfma_f32_16x16x32_bf16 v[56:59], a[216:219], a[120:123], v[56:59]
    v_mfma_f32_16x16x32_bf16 v[60:63], a[220:223], a[120:123], v[60:63]
    ds_write_b128 v215, v[40:43] offset:34816
    s_waitcnt vmcnt(9)
    v_mfma_f32_16x16x32_bf16 v[48:51], a[224:227], a[124:127], v[48:51]
    v_mfma_f32_16x16x32_bf16 v[52:55], a[228:231], a[124:127], v[52:55]
    ds_write_b128 v215, v[44:47] offset:35840
    v_mfma_f32_16x16x32_bf16 v[56:59], a[232:235], a[124:127], v[56:59]
    v_mfma_f32_16x16x32_bf16 v[60:63], a[236:239], a[124:127], v[60:63]
    s_waitcnt vmcnt(8)
    v_mfma_f32_16x16x32_bf16 v[48:51], a[240:243], a[128:131], v[48:51]
    v_mfma_f32_16x16x32_bf16 v[52:55], a[244:247], a[128:131], v[52:55]
    v_mfma_f32_16x16x32_bf16 v[56:59], a[248:251], a[128:131], v[56:59]
    v_mfma_f32_16x16x32_bf16 v[60:63], a[252:255], a[128:131], v[60:63]
    s_waitcnt vmcnt(7)
    v_mfma_f32_16x16x32_bf16 v[48:51], v[128:131], a[132:135], v[48:51]
    v_mfma_f32_16x16x32_bf16 v[52:55], v[132:135], a[132:135], v[52:55]
    v_mfma_f32_16x16x32_bf16 v[56:59], v[136:139], a[132:135], v[56:59]
    v_mfma_f32_16x16x32_bf16 v[60:63], v[140:143], a[132:135], v[60:63]
    s_waitcnt vmcnt(6)
    v_mfma_f32_16x16x32_bf16 v[48:51], v[144:147], a[136:139], v[48:51]
    s_waitcnt lgkmcnt(0)
    s_barrier
    ds_read_b128 v[4:7], v217 offset:32768
    v_mfma_f32_16x16x32_bf16 v[52:55], v[148:151], a[136:139], v[52:55]
    ds_read_b128 v[8:11], v217 offset:33792
    ds_read_b128 v[12:15], v217 offset:34816
    v_mfma_f32_16x16x32_bf16 v[56:59], v[152:155], a[136:139], v[56:59]
    ds_read_b128 v[16:19], v217 offset:35840
    v_mfma_f32_16x16x32_bf16 v[60:63], v[156:159], a[136:139], v[60:63]
    s_waitcnt vmcnt(5)
    v_mfma_f32_16x16x32_bf16 v[48:51], a[0:3], a[140:143], v[48:51]
    v_mfma_f32_16x16x32_bf16 v[52:55], a[4:7], a[140:143], v[52:55]
    v_mfma_f32_16x16x32_bf16 v[56:59], a[8:11], a[140:143], v[56:59]
    v_mfma_f32_16x16x32_bf16 v[60:63], a[12:15], a[140:143], v[60:63]
    s_waitcnt vmcnt(4)
    v_mfma_f32_16x16x32_bf16 v[48:51], a[16:19], a[144:147], v[48:51]
    v_mfma_f32_16x16x32_bf16 v[52:55], a[20:23], a[144:147], v[52:55]
    s_waitcnt vmcnt(3)
    v_mfma_f32_16x16x32_bf16 v[48:51], a[32:35], a[148:151], v[48:51]
    v_mfma_f32_16x16x32_bf16 v[52:55], a[36:39], a[148:151], v[52:55]
    s_waitcnt lgkmcnt(1)
    v_add_f32 v4, v4, v12
    v_add_f32 v5, v5, v13
    s_waitcnt vmcnt(2)
    v_mfma_f32_16x16x32_bf16 v[48:51], a[48:51], a[152:155], v[48:51]
    v_add_f32 v6, v6, v14
    v_add_f32 v7, v7, v15
    v_mfma_f32_16x16x32_bf16 v[52:55], a[52:55], a[152:155], v[52:55]
    s_waitcnt lgkmcnt(0)
    v_add_f32 v8, v8, v16
    v_add_f32 v9, v9, v17
    s_waitcnt vmcnt(1)
    v_mfma_f32_16x16x32_bf16 v[48:51], a[64:67], a[156:159], v[48:51]
    v_add_f32 v10, v10, v18
    v_add_f32 v11, v11, v19
    v_mfma_f32_16x16x32_bf16 v[52:55], a[68:71], a[156:159], v[52:55]
    v_mfma_f32_16x16x32_bf16 v[56:59], a[24:27], a[144:147], v[56:59]
    v_fma_f32 v120, v4, v186, v120
    v_fma_f32 v121, v5, v187, v121
    v_mfma_f32_16x16x32_bf16 v[60:63], a[28:31], a[144:147], v[60:63]
    v_fma_f32 v122, v6, v188, v122
    v_fma_f32 v123, v7, v189, v123
    v_mfma_f32_16x16x32_bf16 v[56:59], a[40:43], a[148:151], v[56:59]
    ds_write_b128 v216, v[48:51] offset:36864
    v_mfma_f32_16x16x32_bf16 v[60:63], a[44:47], a[148:151], v[60:63]
    ds_write_b128 v216, v[52:55] offset:37888
    v_mfma_f32_16x16x32_bf16 v[56:59], a[56:59], a[152:155], v[56:59]
    s_waitcnt lgkmcnt(0)
    s_barrier
    v_fma_f32 v124, v8, v190, v124
    v_mfma_f32_16x16x32_bf16 v[60:63], a[60:63], a[152:155], v[60:63]
    v_fma_f32 v125, v9, v191, v125
    ds_read_b128 v[20:23], v217 offset:36864
    ds_read_b128 v[24:27], v217 offset:37888
    v_mfma_f32_16x16x32_bf16 v[56:59], a[72:75], a[156:159], v[56:59]
    v_fma_f32 v126, v10, v192, v126
    v_fma_f32 v127, v11, v193, v127
    v_mfma_f32_16x16x32_bf16 v[60:63], a[76:79], a[156:159], v[60:63]
    s_waitcnt lgkmcnt(1)
    s_nop 3
    v_pk_add_f32 v[56:57], v[56:57], v[20:21]
    v_pk_add_f32 v[58:59], v[58:59], v[22:23]
    s_waitcnt lgkmcnt(0)
    v_pk_add_f32 v[60:61], v[60:61], v[24:25]
    v_pk_add_f32 v[62:63], v[62:63], v[26:27]
    v_pk_fma_f32 v[56:57], v[56:57], v[186:187], v[120:121]
    v_pk_fma_f32 v[58:59], v[58:59], v[188:189], v[122:123]
    v_pk_fma_f32 v[60:61], v[60:61], v[190:191], v[124:125]
    v_pk_fma_f32 v[62:63], v[62:63], v[192:193], v[126:127]
    v_cvt_pk_bf16_f32 v4, v56, v57
    v_cvt_pk_bf16_f32 v5, v58, v59
    v_cvt_pk_bf16_f32 v6, v60, v61
    v_cvt_pk_bf16_f32 v7, v62, v63
    buffer_store_dwordx4 v[4:7], v234, s[28:31], s43 offen
    s_endpgm
    s_nop 7
L_PS_3:
    s_mov_b32 s40, 20000
L_PT_1:
    buffer_load_dwordx4 v[186:189], v255, s[32:35], s50 offen offset:0 sc1
    buffer_load_dwordx4 v[190:193], v255, s[32:35], s50 offen offset:1024 sc1
    buffer_load_dwordx4 v[194:197], v255, s[32:35], s50 offen offset:2048 sc1
    buffer_load_dwordx4 v[198:201], v255, s[32:35], s50 offen offset:3072 sc1
    s_waitcnt vmcnt(0)
    v_xor_b32 v189, s63, v188
    v_xor_b32 v193, s63, v192
    v_xor_b32 v197, s63, v196
    v_xor_b32 v201, s63, v200
    v_or3_b32 v189, v189, v193, v197
    v_or_b32 v189, v189, v201
    v_cmp_ne_u32 vcc, 0, v189
    s_nop 3
    s_cbranch_vccz L_PD_2
    s_sub_u32 s40, s40, 1
    s_cbranch_scc0 L_PT_1
    s_branch L_PD_2
L_HN12:
    s_branch L_BN1
L_HU12:
    s_branch L_BU1
L_HL12:
    s_branch L_BL1
L_SD_4:
    s_nop 4
    s_lshl_b32 s40, s61, 7
    s_add_u32 s40, s40, 4096
    s_mov_b32 exec_hi, 0
    buffer_store_dword v254, v228, s[32:35], s40 offen sc1
    s_mov_b64 exec, -1
    s_branch L_SX_5
L_WS_7:
    s_mov_b32 s40, 8
L_WA_10:
    buffer_load_dword v239, v228, s[32:35], s59 offen offset:128 sc1
    s_waitcnt vmcnt(0)
    v_cmp_ne_u32 vcc, s96, v239
    s_nop 3
    s_cbranch_vccz L_WD_6
    s_sub_u32 s40, s40, 1
    s_cbranch_scc0 L_WA_10
    s_mov_b64 exec, 2
    buffer_store_dword v254, v255, s[32:35], s58 offen offset:1136 sc1
    s_mov_b64 exec, -1
    s_mov_b32 s40, 20000
L_WF_8:
    buffer_load_dword v239, v228, s[32:35], s59 offen offset:128 sc1
    buffer_load_dword v227, v228, s[32:35], s59 offen offset:1152 sc1
    s_waitcnt vmcnt(0)
    v_xor_b32 v239, s96, v239
    v_xor_b32 v227, s96, v227
    v_min_u32 v239, v239, v227
    v_cmp_lt_u32 vcc, 15, v239
    s_nop 3
    s_cbranch_vccz L_WK_9
    s_sub_u32 s40, s40, 1
    s_cbranch_scc0 L_WF_8
L_WK_9:
    v_cmp_ne_u32 vcc, 0, v239
    s_nop 1
    s_or_b32 s97, vcc_lo, vcc_hi
    s_nop 0
    s_branch L_WD_6
L_PS_14:
    s_mov_b32 s40, 20000
L_PT_12:
    buffer_load_dwordx4 v[92:95], v255, s[32:35], s99 offen offset:0 sc1
    buffer_load_dwordx4 v[96:99], v255, s[32:35], s100 offen offset:0 sc1
    s_waitcnt vmcnt(0)
    v_xor_b32 v95, s63, v94
    v_xor_b32 v99, s63, v98
    v_or_b32 v95, v95, v99
    v_cmp_ne_u32 vcc, 0, v95
    s_nop 3
    s_cbranch_vccz L_PD_13
    s_sub_u32 s40, s40, 1
    s_cbranch_scc0 L_PT_12
    s_branch L_PD_13
L_XS_15:
    s_nop 4
    buffer_store_dword v254, v255, s[32:35], s58 offen offset:240 sc1
    s_branch L_XD_16
L_XS_21:
    s_nop 4
    buffer_store_dword v254, v255, s[32:35], s58 offen offset:368 sc1
    s_branch L_XD_22
L_XS_27:
    s_nop 4
    buffer_store_dword v254, v255, s[32:35], s58 offen offset:496 sc1
    s_branch L_XD_28
L_XS_33:
    s_nop 4
    buffer_store_dword v254, v255, s[32:35], s58 offen offset:624 sc1
    s_branch L_XD_34
L_HN13:
    s_branch L_BN1
L_HU13:
    s_branch L_BU1
L_HL13:
    s_branch L_BL1
L_SD_41:
    s_nop 4
    s_waitcnt vmcnt(30)
    s_mov_b32 s40, 20000
    s_mov_b32 exec_hi, 0
L_EPL_39:
    v_cmp_ne_u32 vcc, s63, v227
    s_nop 3
    s_cbranch_vccz L_EPD_40
    s_mov_b32 s64, 4096
    s_mov_b32 exec_hi, 0
    buffer_load_dword v227, v247, s[32:35], s64 offen sc1
    s_waitcnt vmcnt(0)
    s_sub_u32 s40, s40, 1
    s_cbranch_scc0 L_EPL_39
L_EPD_40:
    s_mov_b64 exec, 1
    buffer_store_dword v254, v255, s[32:35], 0 offen sc1
    s_mov_b64 exec, -1
    s_branch L_SX_42
L_SD_43:
    s_nop 4
    s_mov_b32 s64, 4096
    s_mov_b32 exec_hi, 0
    buffer_load_dword v227, v247, s[32:35], s64 offen sc1
    s_mov_b64 exec, -1
    s_branch L_SX_44
L_XS_45:
    s_nop 4
    buffer_store_dword v254, v255, s[32:35], s58 offen offset:752 sc1
    s_branch L_XD_46
L_XS_51:
    s_nop 4
    buffer_store_dword v254, v255, s[32:35], s58 offen offset:880 sc1
    s_branch L_XD_52
.p2alignl 12, 0xbf810000
L_UH:
    s_add_u32 s32, s32, 251658240
    s_addc_u32 s33, s33, 0
    s_load_dword s46, s[32:33], 0
    v_mov_b32 v202, 0
    v_mov_b32 v203, 0
    v_mov_b32 v204, 0
    v_mov_b32 v205, 0
    v_mov_b32 v206, 0
    v_mov_b32 v207, 0
    v_mov_b32 v208, 0
    v_mov_b32 v209, 0
    v_lshrrev_b32 v136, 3, v241
    v_lshrrev_b32 v137, 1, v136
    v_lshlrev_b32 v137, 5, v137
    v_and_b32 v141, 0x70, v255
    v_xor_b32 v137, v137, v141
    v_and_b32 v138, 4, v136
    v_add_u32 v139, v136, v138
    v_mul_u32_u24 v138, 3072, v139
    v_add_u32 v246, v138, v137
    s_and_b32 s51, s60, 1
    s_lshl_b32 s51, s51, 4
    s_lshr_b32 s52, s60, 1
    s_lshl2_add_u32 s54, s52, s51
    s_mul_i32 s51, s54, 3072
    s_lshl_b32 s52, s62, 7
    s_add_u32 s51, s51, s52
    s_mul_i32 s52, s60, 3072
    s_mov_b32 s34, 16777216
    s_mov_b32 s35, 0x00020000
    s_mov_b32 s14, 524288
    s_mov_b32 s15, 0x00020000
    s_mov_b32 s18, 1409024
    s_mov_b32 s19, 0x00020000
    s_mov_b32 s22, 1409024
    s_mov_b32 s23, 0x00020000
    s_mov_b32 s30, 2097152
    s_mov_b32 s31, 0x00020000
    s_mul_i32 s47, s61, 393216
    s_add_u32 s47, s47, 1048576
    s_add_u32 s59, s47, 360448
    s_lshl2_add_u32 s79, s2, s60
    s_and_b32 s64, s3, 7
    s_lshl_b32 s64, s64, 7
    s_add_u32 s64, s64, s59
    s_load_dword s40, s[32:33], s64
    s_sub_u32 s64, s47, 128
    s_load_dword s40, s[32:33], s64
    s_load_dword s40, s[28:29], 0
    s_load_dword s40, s[12:13], 0
    s_load_dword s40, s[16:17], 0
    s_load_dword s40, s[20:21], 0
    s_and_b32 s64, s3, 31
    s_lshl2_add_u32 s58, s64, s59
    s_mov_b32 s41, 0x3f803f80
    v_lshrrev_b32 v243, 4, v241
    v_and_b32 v242, 15, v241
    s_lshl_b32 s64, s60, 5
    v_xor_b32 v142, s64, v141
    s_lshl_b32 s65, s60, 9
    s_add_u32 s65, s65, 73728
    v_add_u32 v142, s65, v142
    v_mul_u32_u24 v143, 6144, v136
    v_add_u32 v164, v142, v143
    v_xor_b32 v165, 16, v164
    s_lshl_b32 s65, s62, 4
    v_xor_b32 v142, s65, v141
    v_lshl_add_u32 v240, v136, 12, v142
    s_and_b32 s66, s60, 1
    s_lshl_b32 s66, s66, 4
    s_lshr_b32 s65, s60, 1
    s_lshl1_add_u32 s65, s62, s65
    s_add_u32 s66, s66, s65
    s_lshl_b32 s66, s66, 7
    s_add_u32 s82, s47, 327680
    s_add_u32 s82, s82, s66
    s_mov_b32 s50, 32768
    v_lshrrev_b32 v142, 1, v242
    v_xor_b32 v142, v142, v243
    v_lshlrev_b32 v142, 4, v142
    v_lshl_add_u32 v142, v242, 7, v142
    v_add_u32 v235, 73728, v142
    v_xor_b32 v236, 64, v235
    v_bfe_u32 v144, v241, 2, 3
    v_lshrrev_b32 v145, 1, v144
    v_lshlrev_b32 v145, 5, v145
    v_and_b32 v146, 3, v241
    v_lshlrev_b32 v146, 3, v146
    v_lshl_add_u32 v146, v144, 7, v146
    v_lshrrev_b32 v147, 5, v241
    v_mul_u32_u24 v142, 3072, v147
    v_add_u32 v146, v146, v142
    v_xor_b32 v142, s64, v145
    v_add_u32 v248, v146, v142
    v_add_u32 v249, 73728, v248
    v_and_b32 v65, 3, v241
    v_lshlrev_b32 v65, 5, v65
    v_lshl_add_u32 v65, v243, 3, v65
    s_lshl_b32 s65, s60, 7
    s_add_u32 s65, s65, 159744
    v_add_u32 v65, s65, v65
    v_add_u32 v66, 159744, v255
    v_and_b32 v67, 1, v241
    v_lshlrev_b32 v67, 10, v67
    v_lshrrev_b32 v80, 1, v241
    v_lshl_add_u32 v67, v80, 4, v67
    s_lshr_b32 s65, s78, 4
    s_cmp_eq_u32 s65, 1
    s_cselect_b32 s66, 1.0, 0
    s_cmp_eq_u32 s65, 4
    s_cselect_b32 s66, 1.0, s66
    s_mov_b32 s67, s66
    s_lshl_b32 s65, s65, 11
    s_and_b32 s78, s78, 15
    s_lshl_b32 s78, s78, 6
    s_add_u32 s65, s65, s78
    s_add_u32 s65, s65, 32768
    s_lshl_b32 s97, s62, 7
    s_add_u32 s96, s77, s97
    s_add_u32 s97, s76, s97
    s_mov_b64 exec, 0xff
    buffer_load_dword v227, v223, s[4:7], s96 offen
    s_mov_b64 exec, 0x55
    buffer_load_dword v227, v223, s[4:7], s97 offen
    s_mov_b64 exec, -1
    s_lshl4_add_u32 s96, s61, s62
    s_lshl2_add_u32 s96, s96, s60
    s_add_u32 s96, s96, 32
    s_lshl_b32 s96, s96, 10
    buffer_load_dwordx4 v[100:103], v255, s[4:7], s96 offen offset:0
    buffer_load_dwordx4 v[4:7], v255, s[4:7], s76 offen offset:0
    s_waitcnt lgkmcnt(0)
    s_mul_i32 s63, s46, 1664525
    s_add_u32 s63, s63, 1013904223
    v_mov_b32 v254, s63
    s_getreg_b32 s97, hwreg(HW_REG_XCC_ID, 0, 4)
    s_lshl4_add_u32 s96, s63, s97
    v_writelane_b32 v254, s96, 1
    s_mov_b32 s97, 0
    v_mov_b32 v74, s63
    v_mov_b32 v75, s63
    s_waitcnt vmcnt(12)
    v_lshlrev_b32 v210, 16, v64
    v_and_b32 v211, 0xffff0000, v64
    v_mul_f32 v212, 0xbfb8aa3b, v210
    v_mul_f32 v213, 0xbfb8aa3b, v211
    v_exp_f32 v212, v212
    v_exp_f32 v213, v213
    v_add_f32 v212, 1.0, v212
    v_add_f32 v213, 1.0, v213
    v_rcp_f32 v212, v212
    v_rcp_f32 v213, v213
    v_mul_f32 v210, v210, v212
    v_mul_f32 v211, v211, v213
    v_cvt_pk_bf16_f32 v64, v210, v211
    v_and_b32 v210, 0xffff, v64
    v_lshlrev_b32 v211, 16, v64
    v_lshrrev_b32 v212, 16, v64
    v_and_b32 v213, 0xffff0000, v64
    s_waitcnt vmcnt(11)
    v_dot2c_f32_bf16_dpp v202, v210, v0 quad_perm:[0,0,0,0] row_mask:0xf bank_mask:0xf
    v_dot2c_f32_bf16_dpp v203, v211, v0 quad_perm:[0,0,0,0] row_mask:0xf bank_mask:0xf
    v_dot2c_f32_bf16_dpp v204, v210, v1 quad_perm:[0,0,0,0] row_mask:0xf bank_mask:0xf
    v_dot2c_f32_bf16_dpp v205, v211, v1 quad_perm:[0,0,0,0] row_mask:0xf bank_mask:0xf
    v_dot2c_f32_bf16_dpp v206, v210, v2 quad_perm:[0,0,0,0] row_mask:0xf bank_mask:0xf
    buffer_load_dwordx4 v[12:15], v255, s[4:7], s76 offen offset:2048
    v_dot2c_f32_bf16_dpp v207, v211, v2 quad_perm:[0,0,0,0] row_mask:0xf bank_mask:0xf
    v_dot2c_f32_bf16_dpp v208, v210, v3 quad_perm:[0,0,0,0] row_mask:0xf bank_mask:0xf
    v_dot2c_f32_bf16_dpp v209, v211, v3 quad_perm:[0,0,0,0] row_mask:0xf bank_mask:0xf
    s_waitcnt vmcnt(11)
    v_dot2c_f32_bf16_dpp v202, v212, v8 quad_perm:[0,0,0,0] row_mask:0xf bank_mask:0xf
    v_dot2c_f32_bf16_dpp v203, v213, v8 quad_perm:[0,0,0,0] row_mask:0xf bank_mask:0xf
    v_dot2c_f32_bf16_dpp v204, v212, v9 quad_perm:[0,0,0,0] row_mask:0xf bank_mask:0xf
    v_dot2c_f32_bf16_dpp v205, v213, v9 quad_perm:[0,0,0,0] row_mask:0xf bank_mask:0xf
    v_dot2c_f32_bf16_dpp v206, v212, v10 quad_perm:[0,0,0,0] row_mask:0xf bank_mask:0xf
    s_add_u32 s76, s76, 4096
    buffer_load_dwordx4 v[20:23], v255, s[4:7], s76 offen offset:0
    v_dot2c_f32_bf16_dpp v207, v213, v10 quad_perm:[0,0,0,0] row_mask:0xf bank_mask:0xf
    v_dot2c_f32_bf16_dpp v208, v212, v11 quad_perm:[0,0,0,0] row_mask:0xf bank_mask:0xf
    v_dot2c_f32_bf16_dpp v209, v213, v11 quad_perm:[0,0,0,0] row_mask:0xf bank_mask:0xf
    s_waitcnt vmcnt(11)
    v_dot2c_f32_bf16_dpp v202, v210, v16 quad_perm:[1,1,1,1] row_mask:0xf bank_mask:0xf
    v_dot2c_f32_bf16_dpp v203, v211, v16 quad_perm:[1,1,1,1] row_mask:0xf bank_mask:0xf
    v_dot2c_f32_bf16_dpp v204, v210, v17 quad_perm:[1,1,1,1] row_mask:0xf bank_mask:0xf
    v_dot2c_f32_bf16_dpp v205, v211, v17 quad_perm:[1,1,1,1] row_mask:0xf bank_mask:0xf
    v_dot2c_f32_bf16_dpp v206, v210, v18 quad_perm:[1,1,1,1] row_mask:0xf bank_mask:0xf
    v_dot2c_f32_bf16_dpp v207, v211, v18 quad_perm:[1,1,1,1] row_mask:0xf bank_mask:0xf
    buffer_load_dwordx4 v[28:31], v255, s[4:7], s76 offen offset:2048
    v_dot2c_f32_bf16_dpp v208, v210, v19 quad_perm:[1,1,1,1] row_mask:0xf bank_mask:0xf
    v_dot2c_f32_bf16_dpp v209, v211, v19 quad_perm:[1,1,1,1] row_mask:0xf bank_mask:0xf
    s_waitcnt vmcnt(11)
    v_dot2c_f32_bf16_dpp v202, v212, v24 quad_perm:[1,1,1,1] row_mask:0xf bank_mask:0xf
    v_dot2c_f32_bf16_dpp v203, v213, v24 quad_perm:[1,1,1,1] row_mask:0xf bank_mask:0xf
    v_dot2c_f32_bf16_dpp v204, v212, v25 quad_perm:[1,1,1,1] row_mask:0xf bank_mask:0xf
    v_dot2c_f32_bf16_dpp v205, v213, v25 quad_perm:[1,1,1,1] row_mask:0xf bank_mask:0xf
    v_dot2c_f32_bf16_dpp v206, v212, v26 quad_perm:[1,1,1,1] row_mask:0xf bank_mask:0xf
    v_dot2c_f32_bf16_dpp v207, v213, v26 quad_perm:[1,1,1,1] row_mask:0xf bank_mask:0xf
    buffer_load_dwordx4 v[36:39], v255, s[4:7], s77 offen offset:0
    v_dot2c_f32_bf16_dpp v208, v212, v27 quad_perm:[1,1,1,1] row_mask:0xf bank_mask:0xf
    v_dot2c_f32_bf16_dpp v209, v213, v27 quad_perm:[1,1,1,1] row_mask:0xf bank_mask:0xf
    s_waitcnt vmcnt(11)
    v_dot2c_f32_bf16_dpp v202, v210, v32 quad_perm:[2,2,2,2] row_mask:0xf bank_mask:0xf
    v_dot2c_f32_bf16_dpp v203, v211, v32 quad_perm:[2,2,2,2] row_mask:0xf bank_mask:0xf
    v_dot2c_f32_bf16_dpp v204, v210, v33 quad_perm:[2,2,2,2] row_mask:0xf bank_mask:0xf
    v_dot2c_f32_bf16_dpp v205, v211, v33 quad_perm:[2,2,2,2] row_mask:0xf bank_mask:0xf
    v_dot2c_f32_bf16_dpp v206, v210, v34 quad_perm:[2,2,2,2] row_mask:0xf bank_mask:0xf
    v_dot2c_f32_bf16_dpp v207, v211, v34 quad_perm:[2,2,2,2] row_mask:0xf bank_mask:0xf
    v_dot2c_f32_bf16_dpp v208, v210, v35 quad_perm:[2,2,2,2] row_mask:0xf bank_mask:0xf
    buffer_load_dwordx4 v[44:47], v255, s[4:7], s77 offen offset:1024
    v_dot2c_f32_bf16_dpp v209, v211, v35 quad_perm:[2,2,2,2] row_mask:0xf bank_mask:0xf
    s_waitcnt vmcnt(11)
    v_dot2c_f32_bf16_dpp v202, v212, v40 quad_perm:[2,2,2,2] row_mask:0xf bank_mask:0xf
    v_dot2c_f32_bf16_dpp v203, v213, v40 quad_perm:[2,2,2,2] row_mask:0xf bank_mask:0xf
    v_dot2c_f32_bf16_dpp v204, v212, v41 quad_perm:[2,2,2,2] row_mask:0xf bank_mask:0xf
    v_dot2c_f32_bf16_dpp v205, v213, v41 quad_perm:[2,2,2,2] row_mask:0xf bank_mask:0xf
    v_dot2c_f32_bf16_dpp v206, v212, v42 quad_perm:[2,2,2,2] row_mask:0xf bank_mask:0xf
    v_dot2c_f32_bf16_dpp v207, v213, v42 quad_perm:[2,2,2,2] row_mask:0xf bank_mask:0xf
    v_dot2c_f32_bf16_dpp v208, v212, v43 quad_perm:[2,2,2,2] row_mask:0xf bank_mask:0xf
    buffer_load_dwordx4 v[52:55], v255, s[4:7], s77 offen offset:2048
    v_dot2c_f32_bf16_dpp v209, v213, v43 quad_perm:[2,2,2,2] row_mask:0xf bank_mask:0xf
    s_waitcnt vmcnt(11)
    v_dot2c_f32_bf16_dpp v202, v210, v48 quad_perm:[3,3,3,3] row_mask:0xf bank_mask:0xf
    v_dot2c_f32_bf16_dpp v203, v211, v48 quad_perm:[3,3,3,3] row_mask:0xf bank_mask:0xf
    v_dot2c_f32_bf16_dpp v204, v210, v49 quad_perm:[3,3,3,3] row_mask:0xf bank_mask:0xf
    v_dot2c_f32_bf16_dpp v205, v211, v49 quad_perm:[3,3,3,3] row_mask:0xf bank_mask:0xf
    v_dot2c_f32_bf16_dpp v206, v210, v50 quad_perm:[3,3,3,3] row_mask:0xf bank_mask:0xf
    v_dot2c_f32_bf16_dpp v207, v211, v50 quad_perm:[3,3,3,3] row_mask:0xf bank_mask:0xf
    v_dot2c_f32_bf16_dpp v208, v210, v51 quad_perm:[3,3,3,3] row_mask:0xf bank_mask:0xf
    v_dot2c_f32_bf16_dpp v209, v211, v51 quad_perm:[3,3,3,3] row_mask:0xf bank_mask:0xf
    buffer_load_dwordx4 v[60:63], v255, s[4:7], s77 offen offset:3072
    s_waitcnt vmcnt(11)
    v_dot2c_f32_bf16_dpp v202, v212, v56 quad_perm:[3,3,3,3] row_mask:0xf bank_mask:0xf
    v_dot2c_f32_bf16_dpp v203, v213, v56 quad_perm:[3,3,3,3] row_mask:0xf bank_mask:0xf
    v_dot2c_f32_bf16_dpp v204, v212, v57 quad_perm:[3,3,3,3] row_mask:0xf bank_mask:0xf
    v_dot2c_f32_bf16_dpp v205, v213, v57 quad_perm:[3,3,3,3] row_mask:0xf bank_mask:0xf
    v_dot2c_f32_bf16_dpp v206, v212, v58 quad_perm:[3,3,3,3] row_mask:0xf bank_mask:0xf
    v_dot2c_f32_bf16_dpp v207, v213, v58 quad_perm:[3,3,3,3] row_mask:0xf bank_mask:0xf
    v_dot2c_f32_bf16_dpp v208, v212, v59 quad_perm:[3,3,3,3] row_mask:0xf bank_mask:0xf
    v_dot2c_f32_bf16_dpp v209, v213, v59 quad_perm:[3,3,3,3] row_mask:0xf bank_mask:0xf
    v_permlane32_swap_b32 v202, v206
    v_permlane32_swap_b32 v203, v207
    v_permlane32_swap_b32 v204, v208
    v_permlane32_swap_b32 v205, v209
    v_pk_add_f32 v[202:203], v[202:203], v[206:207]
    v_pk_add_f32 v[204:205], v[204:205], v[208:209]
    s_nop 1
    v_permlane16_swap_b32 v202, v204
    v_permlane16_swap_b32 v203, v205
    v_pk_add_f32 v[202:203], v[202:203], v[204:205]
    s_nop 1
    v_add_f32_dpp v202, v202, v202 row_ror:8 row_mask:0xf bank_mask:0xf
    v_add_f32_dpp v203, v203, v203 row_ror:8 row_mask:0xf bank_mask:0xf
    s_nop 0
    v_add_f32_dpp v202, v202, v202 row_ror:4 row_mask:0xf bank_mask:0xf
    v_add_f32_dpp v203, v203, v203 row_ror:4 row_mask:0xf bank_mask:0xf
    ds_write_b64 v65, v[202:203]
    s_cmp_lg_u32 s60, 0
    s_waitcnt lgkmcnt(0)
    s_barrier
    s_cbranch_scc1 L_P0U
    s_mov_b64 exec, 0xff
    ds_read_b128 v[0:3], v66 offset:0
    ds_read_b128 v[8:11], v66 offset:128
    ds_read_b128 v[16:19], v66 offset:256
    ds_read_b128 v[24:27], v66 offset:384
    s_waitcnt lgkmcnt(2)
    v_pk_add_f32 v[0:1], v[0:1], v[8:9]
    v_pk_add_f32 v[2:3], v[2:3], v[10:11]
    s_waitcnt lgkmcnt(0)
    v_pk_add_f32 v[16:17], v[16:17], v[24:25]
    v_pk_add_f32 v[18:19], v[18:19], v[26:27]
    v_pk_add_f32 v[0:1], v[0:1], v[16:17]
    v_pk_add_f32 v[2:3], v[2:3], v[18:19]
    v_cvt_pk_bf16_f32 v0, v0, v1
    v_cvt_pk_bf16_f32 v2, v2, v3
    v_and_b32 v1, 0xffff0000, v0
    v_lshlrev_b32 v0, 16, v0
    v_and_b32 v3, 0xffff0000, v2
    v_lshlrev_b32 v2, 16, v2
    v_pk_add_f32 v[0:1], v[0:1], s[66:67]
    v_pk_add_f32 v[2:3], v[2:3], s[66:67]
    v_cvt_pk_bf16_f32 v72, v0, v1
    v_cvt_pk_bf16_f32 v73, v2, v3
    buffer_store_dwordx4 v[72:75], v67, s[32:35], s65 offen sc1
    s_mov_b64 exec, -1
    s_nop 0
L_P0U:
    v_lshlrev_b32 v148, 2, v243
    s_add_u32 s77, s77, 4096
    buffer_load_dwordx4 v[68:71], v255, s[4:7], s77 offen offset:0
    v_sub_u32 v148, v148, v242
    v_mov_b32 v149, 0xf149f2ca
    s_cmp_eq_u32 s61, 0
    s_cselect_b32 s66, 100, 9
    s_cselect_b32 s67, 100, 1
    v_and_b32 v150, 2, v243
    v_lshlrev_b32 v150, 6, v150
    v_sub_u32 v150, v148, v150
    v_add_u32 v151, 7, v148
    v_add_u32 v152, 0, v148
    v_add_u32 v153, 0, v150
    v_cmp_gt_u32 vcc, 8, v151
    v_cmp_le_i32 s[72:73], 9, v152
    v_cmp_le_i32 s[74:75], s66, v152
    v_cmp_le_i32 s[48:49], s67, v153
    v_cndmask_b32 v166, v149, 0, vcc
    v_cndmask_b32 v156, 0, -1, vcc
    v_cndmask_b32 v170, v149, 0, s[72:73]
    v_cndmask_b32 v174, v149, 0, s[74:75]
    v_cndmask_b32 v178, v149, 0, s[48:49]
    v_add_u32 v151, 8, v148
    v_add_u32 v152, 1, v148
    v_add_u32 v153, 1, v150
    v_cmp_gt_u32 vcc, 8, v151
    v_cmp_le_i32 s[72:73], 9, v152
    v_cmp_le_i32 s[74:75], s66, v152
    v_cmp_le_i32 s[48:49], s67, v153
    v_cndmask_b32 v167, v149, 0, vcc
    v_cndmask_b32 v157, 0, -1, vcc
    v_cndmask_b32 v171, v149, 0, s[72:73]
    v_cndmask_b32 v175, v149, 0, s[74:75]
    buffer_load_dwordx4 v[76:79], v255, s[4:7], s77 offen offset:1024
    v_cndmask_b32 v179, v149, 0, s[48:49]
    v_add_u32 v151, 9, v148
    v_add_u32 v152, 2, v148
    v_add_u32 v153, 2, v150
    v_cmp_gt_u32 vcc, 8, v151
    v_cmp_le_i32 s[72:73], 9, v152
    v_cmp_le_i32 s[74:75], s66, v152
    v_cmp_le_i32 s[48:49], s67, v153
    v_cndmask_b32 v168, v149, 0, vcc
    v_cndmask_b32 v158, 0, -1, vcc
    v_cndmask_b32 v172, v149, 0, s[72:73]
    v_cndmask_b32 v176, v149, 0, s[74:75]
    v_cndmask_b32 v180, v149, 0, s[48:49]
    v_add_u32 v151, 10, v148
    v_add_u32 v152, 3, v148
    v_add_u32 v153, 3, v150
    v_cmp_gt_u32 vcc, 8, v151
    v_cmp_le_i32 s[72:73], 9, v152
    v_cmp_le_i32 s[74:75], s66, v152
    v_cmp_le_i32 s[48:49], s67, v153
    v_cndmask_b32 v169, v149, 0, vcc
    v_cndmask_b32 v159, 0, -1, vcc
    v_cndmask_b32 v173, v149, 0, s[72:73]
    v_cndmask_b32 v177, v149, 0, s[74:75]
    v_cndmask_b32 v181, v149, 0, s[48:49]
    v_mov_b32 v151, 0xffff
    v_bfi_b32 v182, v151, v156, v157
    v_bfi_b32 v183, v151, v158, v159
    v_mov_b32 v184, s41
    buffer_load_dwordx4 v[84:87], v255, s[4:7], s77 offen offset:2048
    v_mov_b32 v185, s41
    v_and_b32 v228, 31, v241
    v_lshlrev_b32 v228, 2, v228
    s_and_b32 s64, s60, 1
    s_lshl_b32 s65, s64, 6
    v_lshlrev_b32 v234, 11, v242
    v_lshl_add_u32 v234, v243, 4, v234
    s_lshr_b32 s66, s60, 1
    s_lshl_b32 s67, s61, 6
    s_add_u32 s67, s67, s66
    s_lshl_b32 s67, s67, 10
    s_lshl_b32 s42, s62, 7
    s_add_u32 s42, s42, s65
    s_lshl_b32 s53, s60, 12
    s_lshl_b32 s84, s60, 13
    s_add_u32 s83, s84, s47
    s_add_u32 s101, s83, 327680
    v_lshlrev_b32 v223, 10, v241
    v_lshl_add_u32 v250, v139, 10, v137
    v_add_u32 v251, 15360, v250
    v_add_u32 v252, 2048, v250
    v_add_u32 v253, 17408, v250
    v_and_b32 v140, 0x30, v255
    v_xor_b32 v140, v140, v145
    v_lshl_add_u32 v140, v144, 7, v140
    v_lshl_add_u32 v140, v147, 10, v140
    v_add_u32 v226, s53, v140
    v_xor_b32 v226, s65, v226
    v_xor_b32 v225, 64, v226
    buffer_load_dwordx4 v[92:95], v255, s[4:7], s77 offen offset:3072
    v_lshlrev_b32 v219, 4, v243
    s_add_u32 s65, s42, 155648
    v_add_u32 v219, s65, v219
    s_add_u32 s42, s42, s67
    s_add_u32 s43, s42, 32768
    s_lshl_b32 s99, s60, 10
    s_add_u32 s99, s99, 36864
    s_add_u32 s100, s99, 4096
    v_add_u32 v237, 49152, v235
    v_add_u32 v238, 49152, v236
    v_mul_u32_u24 v138, 2752, v139
    v_add_u32 v245, v138, v137
    s_min_u32 s65, s62, 3
    s_mul_i32 s55, s62, 5
    s_add_u32 s55, s55, s65
    s_mul_i32 s54, s54, 2752
    s_lshl_b32 s65, s55, 6
    s_add_u32 s54, s54, s65
    v_add_u32 v138, s55, v139
    v_and_b32 v138, 1, v138
    v_lshl_add_u32 v245, v138, 6, v245
    s_cmp_ge_u32 s62, 3
    s_cselect_b32 s65, 64, 0
    v_or_b32 v140, s65, v137
    v_lshrrev_b32 v140, 6, v140
    v_and_b32 v140, v140, v138
    v_mul_u32_u24 v140, 384, v140
    v_sub_u32 v244, v245, v140
    v_add_u32 v244, 256, v244
    s_mov_b32 s44, 0x3eb8aa3b
    s_add_u32 m0, s52, 73728
    s_nop 0
    buffer_load_dwordx4 v246, s[8:11], s51 offen offset:0 lds
    s_mov_b32 s45, 0x3eb8aa3b
    v_lshrrev_b32 v136, 1, v243
    v_lshlrev_b32 v218, 2, v136
    v_lshl_add_u32 v218, v242, 3, v218
    v_lshlrev_b32 v136, 8, v136
    v_lshl_add_u32 v136, v242, 4, v136
    v_and_b32 v137, 1, v243
    v_lshl_add_u32 v233, v137, 14, v136
    v_mul_u32_u24 v137, 45056, v137
    v_add_u32 v232, v137, v136
    s_lshl_b32 s80, s62, 11
    s_add_u32 s80, s80, s47
    s_lshl_b32 s65, s66, 14
    s_add_u32 s81, s80, s65
    s_lshl_b32 s65, s64, 10
    s_add_u32 s81, s81, s65
    s_add_u32 s81, s81, 65536
    s_lshl_b32 s65, s60, 9
    s_add_u32 s80, s80, s65
    s_add_u32 s80, s80, 0
    s_add_u32 s85, s47, 311296
    s_lshl_b32 s65, s66, 11
    s_lshl_b32 s98, s64, 7
    s_add_u32 s98, s98, s65
    s_lshl_b32 s65, s62, 8
    s_add_u32 s98, s98, s65
    s_add_u32 s98, s98, s85
    s_add_u32 s83, s83, 65536
    v_add_u32 v136, s55, v144
    buffer_load_dwordx4 v246, s[8:11], s51 offen offset:1024 lds
    v_and_b32 v136, 1, v136
    v_lshlrev_b32 v136, 1, v136
    s_mul_i32 s64, s60, 3
    v_sub_u32 v136, s64, v136
    v_add_u32 v137, 0, v136
    v_add_u32 v138, 12, v136
    v_min_u32 v137, v137, v138
    v_and_b32 v138, 3, v137
    v_lshlrev_b32 v138, 5, v138
    v_xor_b32 v138, v138, v145
    v_and_b32 v137, 12, v137
    v_lshl_add_u32 v137, v137, 8, v146
    v_add_u32 v229, v137, v138
    v_add_u32 v137, 1, v136
    v_add_u32 v138, 13, v136
    v_min_u32 v137, v137, v138
    v_and_b32 v138, 3, v137
    v_lshlrev_b32 v138, 5, v138
    v_xor_b32 v138, v138, v145
    v_and_b32 v137, 12, v137
    v_lshl_add_u32 v137, v137, 8, v146
    v_add_u32 v230, v137, v138
    v_add_u32 v137, 2, v136
    v_add_u32 v138, 14, v136
    v_min_u32 v137, v137, v138
    v_and_b32 v138, 3, v137
    v_lshlrev_b32 v138, 5, v138
    v_xor_b32 v138, v138, v145
    v_and_b32 v137, 12, v137
    buffer_load_dwordx4 v246, s[8:11], s51 offen offset:2048 lds
    s_add_u32 s51, s51, 98304
    v_lshl_add_u32 v137, v137, 8, v146
    v_add_u32 v231, v137, v138
    s_xor_b32 s65, s60, 3
    s_mul_i32 s65, s65, 6144
    s_add_u32 s65, s65, 90112
    v_add_u32 v214, s65, v255
    s_xor_b32 s65, s60, 2
    s_mul_i32 s65, s65, 6144
    s_add_u32 s65, s65, 90112
    v_add_u32 v215, s65, v255
    s_xor_b32 s65, s60, 1
    s_mul_i32 s65, s65, 6144
    s_add_u32 s65, s65, 90112
    v_add_u32 v216, s65, v255
    s_xor_b32 s65, s60, 0
    s_mul_i32 s65, s65, 6144
    s_add_u32 s65, s65, 90112
    v_add_u32 v217, s65, v255
    s_cmp_eq_u32 s60, 0
    s_cbranch_scc1 L_HU00
    s_cmp_eq_u32 s60, 1
    s_cbranch_scc1 L_HU01
    s_cmp_eq_u32 s60, 2
    s_cbranch_scc1 L_HU02
    s_branch L_HU03
L_BU0:
    s_cmp_eq_u32 s60, 0
    s_cbranch_scc1 L_HU10
    s_cmp_eq_u32 s60, 1
    s_cbranch_scc1 L_HU11
    s_cmp_eq_u32 s60, 2
    s_cbranch_scc1 L_HU12
    s_branch L_HU13
L_BU1:
    s_waitcnt vmcnt(14)
    v_dot2_f32_bf16 v104, s41, v4, 0
    v_dot2_f32_bf16 v120, v4, v4, 0
    s_waitcnt vmcnt(13)
    v_dot2_f32_bf16 v105, s41, v12, 0
    v_dot2_f32_bf16 v121, v12, v12, 0
    v_dot2c_f32_bf16 v104, s41, v5
    v_dot2c_f32_bf16 v120, v5, v5
    v_dot2c_f32_bf16 v105, s41, v13
    v_dot2c_f32_bf16 v121, v13, v13
    v_dot2c_f32_bf16 v104, s41, v6
    s_add_u32 m0, s52, 86016
    s_nop 0
    buffer_load_dwordx4 v246, s[8:11], s51 offen offset:0 lds
    v_dot2c_f32_bf16 v120, v6, v6
    v_dot2c_f32_bf16 v105, s41, v14
    v_dot2c_f32_bf16 v121, v14, v14
    v_dot2c_f32_bf16 v104, s41, v7
    v_dot2c_f32_bf16 v120, v7, v7
    v_dot2c_f32_bf16 v105, s41, v15
    v_dot2c_f32_bf16 v121, v15, v15
    s_waitcnt vmcnt(13)
    v_dot2_f32_bf16 v106, s41, v20, 0
    v_dot2_f32_bf16 v122, v20, v20, 0
    s_waitcnt vmcnt(12)
    v_dot2_f32_bf16 v107, s41, v28, 0
    v_dot2_f32_bf16 v123, v28, v28, 0
    v_dot2c_f32_bf16 v106, s41, v21
    v_dot2c_f32_bf16 v122, v21, v21
    v_dot2c_f32_bf16 v107, s41, v29
    v_dot2c_f32_bf16 v123, v29, v29
    v_dot2c_f32_bf16 v106, s41, v22
    v_dot2c_f32_bf16 v122, v22, v22
    v_dot2c_f32_bf16 v107, s41, v30
    v_dot2c_f32_bf16 v123, v30, v30
    v_dot2c_f32_bf16 v106, s41, v23
    v_dot2c_f32_bf16 v122, v23, v23
    v_dot2c_f32_bf16 v107, s41, v31
    v_dot2c_f32_bf16 v123, v31, v31
    v_lshlrev_b32 v0, 16, v4
    v_and_b32 v1, 0xffff0000, v4
    v_lshlrev_b32 v2, 16, v5
    v_and_b32 v3, 0xffff0000, v5
    v_lshlrev_b32 v4, 16, v6
    v_and_b32 v5, 0xffff0000, v6
    buffer_load_dwordx4 v246, s[8:11], s51 offen offset:1024 lds
    v_lshlrev_b32 v6, 16, v7
    v_and_b32 v7, 0xffff0000, v7
    v_lshlrev_b32 v8, 16, v12
    v_and_b32 v9, 0xffff0000, v12
    v_lshlrev_b32 v10, 16, v13
    v_and_b32 v11, 0xffff0000, v13
    v_lshlrev_b32 v12, 16, v14
    v_and_b32 v13, 0xffff0000, v14
    v_lshlrev_b32 v14, 16, v15
    v_and_b32 v15, 0xffff0000, v15
    s_waitcnt vmcnt(12)
    v_dot2_f32_bf16 v108, s41, v36, 0
    v_dot2_f32_bf16 v124, v36, v36, 0
    s_waitcnt vmcnt(11)
    v_dot2_f32_bf16 v109, s41, v44, 0
    v_dot2_f32_bf16 v125, v44, v44, 0
    v_dot2c_f32_bf16 v108, s41, v37
    v_dot2c_f32_bf16 v124, v37, v37
    v_dot2c_f32_bf16 v109, s41, v45
    v_dot2c_f32_bf16 v125, v45, v45
    v_dot2c_f32_bf16 v108, s41, v38
    v_dot2c_f32_bf16 v124, v38, v38
    v_dot2c_f32_bf16 v109, s41, v46
    v_dot2c_f32_bf16 v125, v46, v46
    v_dot2c_f32_bf16 v108, s41, v39
    v_dot2c_f32_bf16 v124, v39, v39
    v_dot2c_f32_bf16 v109, s41, v47
    v_dot2c_f32_bf16 v125, v47, v47
    v_lshlrev_b32 v16, 16, v20
    v_and_b32 v17, 0xffff0000, v20
    v_lshlrev_b32 v18, 16, v21
    buffer_load_dwordx4 v246, s[8:11], s51 offen offset:2048 lds
    s_add_u32 s51, s51, 98304
    v_and_b32 v19, 0xffff0000, v21
    v_lshlrev_b32 v20, 16, v22
    v_and_b32 v21, 0xffff0000, v22
    v_lshlrev_b32 v22, 16, v23
    v_and_b32 v23, 0xffff0000, v23
    v_lshlrev_b32 v24, 16, v28
    v_and_b32 v25, 0xffff0000, v28
    v_lshlrev_b32 v26, 16, v29
    v_and_b32 v27, 0xffff0000, v29
    v_lshlrev_b32 v28, 16, v30
    v_and_b32 v29, 0xffff0000, v30
    v_lshlrev_b32 v30, 16, v31
    v_and_b32 v31, 0xffff0000, v31
    s_waitcnt vmcnt(11)
    v_dot2_f32_bf16 v110, s41, v52, 0
    v_dot2_f32_bf16 v126, v52, v52, 0
    s_waitcnt vmcnt(10)
    v_dot2_f32_bf16 v111, s41, v60, 0
    v_dot2_f32_bf16 v127, v60, v60, 0
    v_dot2c_f32_bf16 v110, s41, v53
    v_dot2c_f32_bf16 v126, v53, v53
    v_dot2c_f32_bf16 v111, s41, v61
    v_dot2c_f32_bf16 v127, v61, v61
    v_dot2c_f32_bf16 v110, s41, v54
    v_dot2c_f32_bf16 v126, v54, v54
    v_dot2c_f32_bf16 v111, s41, v62
    v_dot2c_f32_bf16 v127, v62, v62
    v_dot2c_f32_bf16 v110, s41, v55
    v_dot2c_f32_bf16 v126, v55, v55
    v_dot2c_f32_bf16 v111, s41, v63
    v_dot2c_f32_bf16 v127, v63, v63
    s_waitcnt vmcnt(6)
    s_nop 0
    s_branch L_J
.p2alignl 12, 0xbf810000
L_LP:
L_LH:
    s_add_u32 s32, s32, 251658240
    s_addc_u32 s33, s33, 0
    s_load_dword s46, s[32:33], 0
    v_mov_b32 v202, 0
    v_mov_b32 v203, 0
    v_mov_b32 v204, 0
    v_mov_b32 v205, 0
    v_mov_b32 v206, 0
    v_mov_b32 v207, 0
    v_mov_b32 v208, 0
    v_mov_b32 v209, 0
    v_lshrrev_b32 v136, 3, v241
    v_lshrrev_b32 v137, 1, v136
    v_lshlrev_b32 v137, 5, v137
    v_and_b32 v141, 0x70, v255
    v_xor_b32 v137, v137, v141
    v_and_b32 v138, 4, v136
    v_add_u32 v139, v136, v138
    v_mul_u32_u24 v138, 3072, v139
    v_add_u32 v246, v138, v137
    s_and_b32 s51, s60, 1
    s_lshl_b32 s51, s51, 4
    s_lshr_b32 s52, s60, 1
    s_lshl2_add_u32 s54, s52, s51
    s_mul_i32 s51, s54, 3072
    s_lshl_b32 s52, s62, 7
    s_add_u32 s51, s51, s52
    s_mul_i32 s52, s60, 3072
    s_mov_b32 s34, 16777216
    s_mov_b32 s35, 0x00020000
    s_mov_b32 s14, 524288
    s_mov_b32 s15, 0x00020000
    s_mov_b32 s18, 1409024
    s_mov_b32 s19, 0x00020000
    s_mov_b32 s22, 1409024
    s_mov_b32 s23, 0x00020000
    s_mov_b32 s30, 2097152
    s_mov_b32 s31, 0x00020000
    s_mul_i32 s47, s61, 393216
    s_add_u32 s47, s47, 1048576
    s_add_u32 s59, s47, 360448
    s_lshl2_add_u32 s79, s2, s60
    s_and_b32 s64, s3, 7
    s_lshl_b32 s64, s64, 7
    s_add_u32 s64, s64, s59
    s_load_dword s40, s[32:33], s64
    s_sub_u32 s64, s47, 128
    s_load_dword s40, s[32:33], s64
    s_load_dword s40, s[28:29], 0
    s_load_dword s40, s[12:13], 0
    s_load_dword s40, s[16:17], 0
    s_load_dword s40, s[20:21], 0
    s_and_b32 s64, s3, 31
    s_lshl2_add_u32 s58, s64, s59
    s_mov_b32 s41, 0x3f803f80
    v_lshrrev_b32 v243, 4, v241
    v_and_b32 v242, 15, v241
    s_lshl_b32 s64, s60, 5
    v_xor_b32 v142, s64, v141
    s_lshl_b32 s65, s60, 9
    s_add_u32 s65, s65, 73728
    v_add_u32 v142, s65, v142
    v_mul_u32_u24 v143, 6144, v136
    v_add_u32 v164, v142, v143
    v_xor_b32 v165, 16, v164
    s_lshl_b32 s65, s62, 4
    v_xor_b32 v142, s65, v141
    v_lshl_add_u32 v240, v136, 12, v142
    s_and_b32 s66, s60, 1
    s_lshl_b32 s66, s66, 4
    s_lshr_b32 s65, s60, 1
    s_lshl1_add_u32 s65, s62, s65
    s_add_u32 s66, s66, s65
    s_lshl_b32 s66, s66, 7
    s_add_u32 s82, s47, 327680
    s_add_u32 s82, s82, s66
    s_mov_b32 s50, 32768
    v_lshrrev_b32 v142, 1, v242
    v_xor_b32 v142, v142, v243
    v_lshlrev_b32 v142, 4, v142
    v_lshl_add_u32 v142, v242, 7, v142
    v_add_u32 v235, 73728, v142
    v_xor_b32 v236, 64, v235
    v_bfe_u32 v144, v241, 2, 3
    v_lshrrev_b32 v145, 1, v144
    v_lshlrev_b32 v145, 5, v145
    v_and_b32 v146, 3, v241
    v_lshlrev_b32 v146, 3, v146
    v_lshl_add_u32 v146, v144, 7, v146
    v_lshrrev_b32 v147, 5, v241
    v_mul_u32_u24 v142, 3072, v147
    v_add_u32 v146, v146, v142
    v_xor_b32 v142, s64, v145
    v_add_u32 v248, v146, v142
    v_add_u32 v249, 73728, v248
    v_lshlrev_b32 v148, 2, v243
    v_sub_u32 v148, v148, v242
    v_mov_b32 v149, 0xf149f2ca
    s_cmp_eq_u32 s61, 0
    s_cselect_b32 s66, 100, 9
    s_cselect_b32 s67, 100, 1
    v_and_b32 v150, 2, v243
    v_lshlrev_b32 v150, 6, v150
    v_sub_u32 v150, v148, v150
    v_add_u32 v151, 7, v148
    v_add_u32 v152, 0, v148
    v_add_u32 v153, 0, v150
    v_cmp_gt_u32 vcc, 8, v151
    v_cmp_le_i32 s[72:73], 9, v152
    v_cmp_le_i32 s[74:75], s66, v152
    v_cmp_le_i32 s[48:49], s67, v153
    v_cndmask_b32 v166, v149, 0, vcc
    v_cndmask_b32 v156, 0, -1, vcc
    v_cndmask_b32 v170, v149, 0, s[72:73]
    v_cndmask_b32 v174, v149, 0, s[74:75]
    v_cndmask_b32 v178, v149, 0, s[48:49]
    s_lshl_b32 s97, s62, 7
    s_add_u32 s96, s77, s97
    s_add_u32 s97, s76, s97
    s_mov_b64 exec, 0xff
    buffer_load_dword v227, v223, s[4:7], s96 offen
    s_mov_b64 exec, 0x55
    buffer_load_dword v227, v223, s[4:7], s97 offen
    s_mov_b64 exec, -1
    v_add_u32 v151, 8, v148
    v_add_u32 v152, 1, v148
    v_add_u32 v153, 1, v150
    v_cmp_gt_u32 vcc, 8, v151
    v_cmp_le_i32 s[72:73], 9, v152
    v_cmp_le_i32 s[74:75], s66, v152
    v_cmp_le_i32 s[48:49], s67, v153
    v_cndmask_b32 v167, v149, 0, vcc
    v_cndmask_b32 v157, 0, -1, vcc
    v_cndmask_b32 v171, v149, 0, s[72:73]
    v_cndmask_b32 v175, v149, 0, s[74:75]
    v_cndmask_b32 v179, v149, 0, s[48:49]
    v_add_u32 v151, 9, v148
    v_add_u32 v152, 2, v148
    v_add_u32 v153, 2, v150
    v_cmp_gt_u32 vcc, 8, v151
    v_cmp_le_i32 s[72:73], 9, v152
    v_cmp_le_i32 s[74:75], s66, v152
    v_cmp_le_i32 s[48:49], s67, v153
    v_cndmask_b32 v168, v149, 0, vcc
    v_cndmask_b32 v158, 0, -1, vcc
    v_cndmask_b32 v172, v149, 0, s[72:73]
    v_cndmask_b32 v176, v149, 0, s[74:75]
    v_cndmask_b32 v180, v149, 0, s[48:49]
    v_add_u32 v151, 10, v148
    v_add_u32 v152, 3, v148
    v_add_u32 v153, 3, v150
    v_cmp_gt_u32 vcc, 8, v151
    v_cmp_le_i32 s[72:73], 9, v152
    v_cmp_le_i32 s[74:75], s66, v152
    v_cmp_le_i32 s[48:49], s67, v153
    v_cndmask_b32 v169, v149, 0, vcc
    v_cndmask_b32 v159, 0, -1, vcc
    v_cndmask_b32 v173, v149, 0, s[72:73]
    v_cndmask_b32 v177, v149, 0, s[74:75]
    v_cndmask_b32 v181, v149, 0, s[48:49]
    v_mov_b32 v151, 0xffff
    v_bfi_b32 v182, v151, v156, v157
    v_bfi_b32 v183, v151, v158, v159
    v_mov_b32 v184, s41
    v_mov_b32 v185, s41
    v_and_b32 v228, 31, v241
    v_lshlrev_b32 v228, 2, v228
    s_and_b32 s64, s60, 1
    s_lshl_b32 s65, s64, 6
    v_lshlrev_b32 v234, 11, v242
    v_lshl_add_u32 v234, v243, 4, v234
    s_lshr_b32 s66, s60, 1
    s_lshl_b32 s67, s61, 6
    s_add_u32 s67, s67, s66
    s_lshl_b32 s67, s67, 10
    s_lshl_b32 s42, s62, 7
    s_add_u32 s42, s42, s65
    s_lshl_b32 s53, s60, 12
    s_lshl_b32 s84, s60, 13
    s_add_u32 s83, s84, s47
    s_add_u32 s101, s83, 327680
    v_lshlrev_b32 v223, 10, v241
    v_lshl_add_u32 v250, v139, 10, v137
    v_add_u32 v251, 15360, v250
    v_add_u32 v252, 2048, v250
    v_add_u32 v253, 17408, v250
    v_and_b32 v140, 0x30, v255
    v_xor_b32 v140, v140, v145
    v_lshl_add_u32 v140, v144, 7, v140
    s_lshl4_add_u32 s96, s61, s62
    s_lshl2_add_u32 s96, s96, s60
    s_add_u32 s96, s96, 32
    s_lshl_b32 s96, s96, 10
    buffer_load_dwordx4 v[100:103], v255, s[4:7], s96 offen offset:0
    v_lshl_add_u32 v140, v147, 10, v140
    v_add_u32 v226, s53, v140
    v_xor_b32 v226, s65, v226
    v_xor_b32 v225, 64, v226
    v_lshlrev_b32 v219, 4, v243
    s_add_u32 s65, s42, 155648
    v_add_u32 v219, s65, v219
    s_add_u32 s42, s42, s67
    s_add_u32 s43, s42, 32768
    s_lshl_b32 s99, s60, 10
    s_add_u32 s99, s99, 36864
    s_add_u32 s100, s99, 4096
    v_add_u32 v237, 49152, v235
    v_add_u32 v238, 49152, v236
    v_mul_u32_u24 v138, 2752, v139
    v_add_u32 v245, v138, v137
    s_min_u32 s65, s62, 3
    s_mul_i32 s55, s62, 5
    s_add_u32 s55, s55, s65
    s_mul_i32 s54, s54, 2752
    s_lshl_b32 s65, s55, 6
    s_add_u32 s54, s54, s65
    v_add_u32 v138, s55, v139
    v_and_b32 v138, 1, v138
    v_lshl_add_u32 v245, v138, 6, v245
    s_cmp_ge_u32 s62, 3
    s_cselect_b32 s65, 64, 0
    v_or_b32 v140, s65, v137
    v_lshrrev_b32 v140, 6, v140
    v_and_b32 v140, v140, v138
    v_mul_u32_u24 v140, 384, v140
    v_sub_u32 v244, v245, v140
    v_add_u32 v244, 256, v244
    s_mov_b32 s44, 0x3eb8aa3b
    s_mov_b32 s45, 0x3eb8aa3b
    v_lshrrev_b32 v136, 1, v243
    v_lshlrev_b32 v218, 2, v136
    v_lshl_add_u32 v218, v242, 3, v218
    v_lshlrev_b32 v136, 8, v136
    v_lshl_add_u32 v136, v242, 4, v136
    v_and_b32 v137, 1, v243
    v_lshl_add_u32 v233, v137, 14, v136
    v_mul_u32_u24 v137, 45056, v137
    v_add_u32 v232, v137, v136
    s_lshl_b32 s80, s62, 11
    s_add_u32 s80, s80, s47
    s_lshl_b32 s65, s66, 14
    s_add_u32 s81, s80, s65
    s_lshl_b32 s65, s64, 10
    s_add_u32 s81, s81, s65
    s_add_u32 s81, s81, 65536
    s_lshl_b32 s65, s60, 9
    s_add_u32 s80, s80, s65
    s_add_u32 s80, s80, 0
    s_add_u32 s85, s47, 311296
    s_lshl_b32 s65, s66, 11
    s_lshl_b32 s98, s64, 7
    s_add_u32 s98, s98, s65
    s_lshl_b32 s65, s62, 8
    s_add_u32 s98, s98, s65
    s_add_u32 s98, s98, s85
    s_add_u32 s83, s83, 65536
    v_add_u32 v136, s55, v144
    v_and_b32 v136, 1, v136
    v_lshlrev_b32 v136, 1, v136
    s_mul_i32 s64, s60, 3
    buffer_load_dwordx4 v[4:7], v255, s[4:7], s76 offen offset:0
    v_sub_u32 v136, s64, v136
    v_add_u32 v137, 0, v136
    v_add_u32 v138, 12, v136
    v_min_u32 v137, v137, v138
    v_and_b32 v138, 3, v137
    v_lshlrev_b32 v138, 5, v138
    v_xor_b32 v138, v138, v145
    v_and_b32 v137, 12, v137
    v_lshl_add_u32 v137, v137, 8, v146
    v_add_u32 v229, v137, v138
    v_add_u32 v137, 1, v136
    v_add_u32 v138, 13, v136
    v_min_u32 v137, v137, v138
    v_and_b32 v138, 3, v137
    v_lshlrev_b32 v138, 5, v138
    v_xor_b32 v138, v138, v145
    v_and_b32 v137, 12, v137
    v_lshl_add_u32 v137, v137, 8, v146
    v_add_u32 v230, v137, v138
    v_add_u32 v137, 2, v136
    v_add_u32 v138, 14, v136
    v_min_u32 v137, v137, v138
    v_and_b32 v138, 3, v137
    v_lshlrev_b32 v138, 5, v138
    v_xor_b32 v138, v138, v145
    v_and_b32 v137, 12, v137
    v_lshl_add_u32 v137, v137, 8, v146
    v_add_u32 v231, v137, v138
    s_xor_b32 s65, s60, 3
    s_mul_i32 s65, s65, 6144
    s_add_u32 s65, s65, 90112
    v_add_u32 v214, s65, v255
    s_xor_b32 s65, s60, 2
    s_mul_i32 s65, s65, 6144
    s_add_u32 s65, s65, 90112
    v_add_u32 v215, s65, v255
    s_xor_b32 s65, s60, 1
    s_mul_i32 s65, s65, 6144
    s_add_u32 s65, s65, 90112
    v_add_u32 v216, s65, v255
    s_xor_b32 s65, s60, 0
    s_mul_i32 s65, s65, 6144
    s_add_u32 s65, s65, 90112
    v_add_u32 v217, s65, v255
    v_and_b32 v65, 3, v241
    v_lshlrev_b32 v65, 5, v65
    v_lshl_add_u32 v65, v243, 3, v65
    s_lshl_b32 s65, s60, 7
    s_add_u32 s65, s65, 159744
    v_add_u32 v65, s65, v65
    v_add_u32 v66, 159744, v255
    v_and_b32 v67, 1, v241
    v_lshlrev_b32 v67, 10, v67
    v_lshrrev_b32 v80, 1, v241
    v_lshl_add_u32 v67, v80, 4, v67
    s_lshr_b32 s65, s78, 4
    s_cmp_eq_u32 s65, 1
    s_cselect_b32 s66, 1.0, 0
    s_cmp_eq_u32 s65, 4
    s_cselect_b32 s66, 1.0, s66
    s_mov_b32 s67, s66
    s_lshl_b32 s65, s65, 11
    s_and_b32 s78, s78, 15
    s_lshl_b32 s78, s78, 6
    s_add_u32 s65, s65, s78
    s_add_u32 s65, s65, 32768
    s_cmp_eq_u32 s60, 0
    s_cbranch_scc1 L_HL00
    s_cmp_eq_u32 s60, 1
    s_cbranch_scc1 L_HL01
    s_cmp_eq_u32 s60, 2
    s_cbranch_scc1 L_HL02
    s_branch L_HL03
L_BL0:
    s_cmp_eq_u32 s60, 0
    s_cbranch_scc1 L_HL10
    s_cmp_eq_u32 s60, 1
    s_cbranch_scc1 L_HL11
    s_cmp_eq_u32 s60, 2
    s_cbranch_scc1 L_HL12
    s_branch L_HL13
L_BL1:
    s_waitcnt lgkmcnt(0)
    s_mul_i32 s63, s46, 1664525
    s_add_u32 s63, s63, 1013904223
    v_mov_b32 v254, s63
    s_getreg_b32 s97, hwreg(HW_REG_XCC_ID, 0, 4)
    s_lshl4_add_u32 s96, s63, s97
    v_writelane_b32 v254, s96, 1
    s_mov_b32 s97, 0
    v_mov_b32 v74, s63
    v_mov_b32 v75, s63
    s_waitcnt vmcnt(12)
    v_lshlrev_b32 v210, 16, v64
    v_and_b32 v211, 0xffff0000, v64
    v_mul_f32 v212, 0xbfb8aa3b, v210
    v_mul_f32 v213, 0xbfb8aa3b, v211
    v_exp_f32 v212, v212
    v_exp_f32 v213, v213
    v_add_f32 v212, 1.0, v212
    v_add_f32 v213, 1.0, v213
    v_rcp_f32 v212, v212
    v_rcp_f32 v213, v213
    v_mul_f32 v210, v210, v212
    v_mul_f32 v211, v211, v213
    v_cvt_pk_bf16_f32 v64, v210, v211
    v_and_b32 v210, 0xffff, v64
    v_lshlrev_b32 v211, 16, v64
    v_lshrrev_b32 v212, 16, v64
    v_and_b32 v213, 0xffff0000, v64
    s_waitcnt vmcnt(11)
    v_dot2c_f32_bf16_dpp v202, v210, v0 quad_perm:[0,0,0,0] row_mask:0xf bank_mask:0xf
    v_dot2c_f32_bf16_dpp v203, v211, v0 quad_perm:[0,0,0,0] row_mask:0xf bank_mask:0xf
    v_dot2c_f32_bf16_dpp v204, v210, v1 quad_perm:[0,0,0,0] row_mask:0xf bank_mask:0xf
    v_dot2c_f32_bf16_dpp v205, v211, v1 quad_perm:[0,0,0,0] row_mask:0xf bank_mask:0xf
    v_dot2c_f32_bf16_dpp v206, v210, v2 quad_perm:[0,0,0,0] row_mask:0xf bank_mask:0xf
    buffer_load_dwordx4 v[12:15], v255, s[4:7], s76 offen offset:2048
    v_dot2c_f32_bf16_dpp v207, v211, v2 quad_perm:[0,0,0,0] row_mask:0xf bank_mask:0xf
    v_dot2c_f32_bf16_dpp v208, v210, v3 quad_perm:[0,0,0,0] row_mask:0xf bank_mask:0xf
    v_dot2c_f32_bf16_dpp v209, v211, v3 quad_perm:[0,0,0,0] row_mask:0xf bank_mask:0xf
    s_waitcnt vmcnt(11)
    v_dot2c_f32_bf16_dpp v202, v212, v8 quad_perm:[0,0,0,0] row_mask:0xf bank_mask:0xf
    v_dot2c_f32_bf16_dpp v203, v213, v8 quad_perm:[0,0,0,0] row_mask:0xf bank_mask:0xf
    v_dot2c_f32_bf16_dpp v204, v212, v9 quad_perm:[0,0,0,0] row_mask:0xf bank_mask:0xf
    s_add_u32 s76, s76, 4096
    buffer_load_dwordx4 v[20:23], v255, s[4:7], s76 offen offset:0
    v_dot2c_f32_bf16_dpp v205, v213, v9 quad_perm:[0,0,0,0] row_mask:0xf bank_mask:0xf
    v_dot2c_f32_bf16_dpp v206, v212, v10 quad_perm:[0,0,0,0] row_mask:0xf bank_mask:0xf
    v_dot2c_f32_bf16_dpp v207, v213, v10 quad_perm:[0,0,0,0] row_mask:0xf bank_mask:0xf
    v_dot2c_f32_bf16_dpp v208, v212, v11 quad_perm:[0,0,0,0] row_mask:0xf bank_mask:0xf
    v_dot2c_f32_bf16_dpp v209, v213, v11 quad_perm:[0,0,0,0] row_mask:0xf bank_mask:0xf
    s_waitcnt vmcnt(11)
    v_dot2c_f32_bf16_dpp v202, v210, v16 quad_perm:[1,1,1,1] row_mask:0xf bank_mask:0xf
    v_dot2c_f32_bf16_dpp v203, v211, v16 quad_perm:[1,1,1,1] row_mask:0xf bank_mask:0xf
    buffer_load_dwordx4 v[28:31], v255, s[4:7], s76 offen offset:2048
    v_dot2c_f32_bf16_dpp v204, v210, v17 quad_perm:[1,1,1,1] row_mask:0xf bank_mask:0xf
    v_dot2c_f32_bf16_dpp v205, v211, v17 quad_perm:[1,1,1,1] row_mask:0xf bank_mask:0xf
    v_dot2c_f32_bf16_dpp v206, v210, v18 quad_perm:[1,1,1,1] row_mask:0xf bank_mask:0xf
    v_dot2c_f32_bf16_dpp v207, v211, v18 quad_perm:[1,1,1,1] row_mask:0xf bank_mask:0xf
    v_dot2c_f32_bf16_dpp v208, v210, v19 quad_perm:[1,1,1,1] row_mask:0xf bank_mask:0xf
    v_dot2c_f32_bf16_dpp v209, v211, v19 quad_perm:[1,1,1,1] row_mask:0xf bank_mask:0xf
    s_waitcnt vmcnt(11)
    v_dot2c_f32_bf16_dpp v202, v212, v24 quad_perm:[1,1,1,1] row_mask:0xf bank_mask:0xf
    buffer_load_dwordx4 v[36:39], v255, s[4:7], s77 offen offset:0
    v_dot2c_f32_bf16_dpp v203, v213, v24 quad_perm:[1,1,1,1] row_mask:0xf bank_mask:0xf
    v_dot2c_f32_bf16_dpp v204, v212, v25 quad_perm:[1,1,1,1] row_mask:0xf bank_mask:0xf
    v_dot2c_f32_bf16_dpp v205, v213, v25 quad_perm:[1,1,1,1] row_mask:0xf bank_mask:0xf
    v_dot2c_f32_bf16_dpp v206, v212, v26 quad_perm:[1,1,1,1] row_mask:0xf bank_mask:0xf
    v_dot2c_f32_bf16_dpp v207, v213, v26 quad_perm:[1,1,1,1] row_mask:0xf bank_mask:0xf
    v_dot2c_f32_bf16_dpp v208, v212, v27 quad_perm:[1,1,1,1] row_mask:0xf bank_mask:0xf
    buffer_load_dwordx4 v[44:47], v255, s[4:7], s77 offen offset:1024
    v_dot2c_f32_bf16_dpp v209, v213, v27 quad_perm:[1,1,1,1] row_mask:0xf bank_mask:0xf
    s_waitcnt vmcnt(12)
    v_dot2c_f32_bf16_dpp v202, v210, v32 quad_perm:[2,2,2,2] row_mask:0xf bank_mask:0xf
    v_dot2c_f32_bf16_dpp v203, v211, v32 quad_perm:[2,2,2,2] row_mask:0xf bank_mask:0xf
    v_dot2c_f32_bf16_dpp v204, v210, v33 quad_perm:[2,2,2,2] row_mask:0xf bank_mask:0xf
    v_dot2c_f32_bf16_dpp v205, v211, v33 quad_perm:[2,2,2,2] row_mask:0xf bank_mask:0xf
    v_dot2c_f32_bf16_dpp v206, v210, v34 quad_perm:[2,2,2,2] row_mask:0xf bank_mask:0xf
    v_dot2c_f32_bf16_dpp v207, v211, v34 quad_perm:[2,2,2,2] row_mask:0xf bank_mask:0xf
    buffer_load_dwordx4 v[52:55], v255, s[4:7], s77 offen offset:2048
    v_dot2c_f32_bf16_dpp v208, v210, v35 quad_perm:[2,2,2,2] row_mask:0xf bank_mask:0xf
    v_dot2c_f32_bf16_dpp v209, v211, v35 quad_perm:[2,2,2,2] row_mask:0xf bank_mask:0xf
    s_waitcnt vmcnt(12)
    v_dot2c_f32_bf16_dpp v202, v212, v40 quad_perm:[2,2,2,2] row_mask:0xf bank_mask:0xf
    v_dot2c_f32_bf16_dpp v203, v213, v40 quad_perm:[2,2,2,2] row_mask:0xf bank_mask:0xf
    v_dot2c_f32_bf16_dpp v204, v212, v41 quad_perm:[2,2,2,2] row_mask:0xf bank_mask:0xf
    v_dot2c_f32_bf16_dpp v205, v213, v41 quad_perm:[2,2,2,2] row_mask:0xf bank_mask:0xf
    v_dot2c_f32_bf16_dpp v206, v212, v42 quad_perm:[2,2,2,2] row_mask:0xf bank_mask:0xf
    buffer_load_dwordx4 v[60:63], v255, s[4:7], s77 offen offset:3072
    v_dot2c_f32_bf16_dpp v207, v213, v42 quad_perm:[2,2,2,2] row_mask:0xf bank_mask:0xf
    v_dot2c_f32_bf16_dpp v208, v212, v43 quad_perm:[2,2,2,2] row_mask:0xf bank_mask:0xf
    v_dot2c_f32_bf16_dpp v209, v213, v43 quad_perm:[2,2,2,2] row_mask:0xf bank_mask:0xf
    s_waitcnt vmcnt(12)
    v_dot2c_f32_bf16_dpp v202, v210, v48 quad_perm:[3,3,3,3] row_mask:0xf bank_mask:0xf
    v_dot2c_f32_bf16_dpp v203, v211, v48 quad_perm:[3,3,3,3] row_mask:0xf bank_mask:0xf
    v_dot2c_f32_bf16_dpp v204, v210, v49 quad_perm:[3,3,3,3] row_mask:0xf bank_mask:0xf
    s_add_u32 s77, s77, 4096
    buffer_load_dwordx4 v[68:71], v255, s[4:7], s77 offen offset:0
    v_dot2c_f32_bf16_dpp v205, v211, v49 quad_perm:[3,3,3,3] row_mask:0xf bank_mask:0xf
    v_dot2c_f32_bf16_dpp v206, v210, v50 quad_perm:[3,3,3,3] row_mask:0xf bank_mask:0xf
    v_dot2c_f32_bf16_dpp v207, v211, v50 quad_perm:[3,3,3,3] row_mask:0xf bank_mask:0xf
    v_dot2c_f32_bf16_dpp v208, v210, v51 quad_perm:[3,3,3,3] row_mask:0xf bank_mask:0xf
    v_dot2c_f32_bf16_dpp v209, v211, v51 quad_perm:[3,3,3,3] row_mask:0xf bank_mask:0xf
    s_waitcnt vmcnt(12)
    v_dot2c_f32_bf16_dpp v202, v212, v56 quad_perm:[3,3,3,3] row_mask:0xf bank_mask:0xf
    v_dot2c_f32_bf16_dpp v203, v213, v56 quad_perm:[3,3,3,3] row_mask:0xf bank_mask:0xf
    buffer_load_dwordx4 v[76:79], v255, s[4:7], s77 offen offset:1024
    v_dot2c_f32_bf16_dpp v204, v212, v57 quad_perm:[3,3,3,3] row_mask:0xf bank_mask:0xf
    v_dot2c_f32_bf16_dpp v205, v213, v57 quad_perm:[3,3,3,3] row_mask:0xf bank_mask:0xf
    v_dot2c_f32_bf16_dpp v206, v212, v58 quad_perm:[3,3,3,3] row_mask:0xf bank_mask:0xf
    v_dot2c_f32_bf16_dpp v207, v213, v58 quad_perm:[3,3,3,3] row_mask:0xf bank_mask:0xf
    v_dot2c_f32_bf16_dpp v208, v212, v59 quad_perm:[3,3,3,3] row_mask:0xf bank_mask:0xf
    v_dot2c_f32_bf16_dpp v209, v213, v59 quad_perm:[3,3,3,3] row_mask:0xf bank_mask:0xf
    v_permlane32_swap_b32 v202, v206
    v_permlane32_swap_b32 v203, v207
    v_permlane32_swap_b32 v204, v208
    v_permlane32_swap_b32 v205, v209
    v_pk_add_f32 v[202:203], v[202:203], v[206:207]
    v_pk_add_f32 v[204:205], v[204:205], v[208:209]
    s_nop 1
    v_permlane16_swap_b32 v202, v204
    v_permlane16_swap_b32 v203, v205
    v_pk_add_f32 v[202:203], v[202:203], v[204:205]
    s_nop 1
    v_add_f32_dpp v202, v202, v202 row_ror:8 row_mask:0xf bank_mask:0xf
    v_add_f32_dpp v203, v203, v203 row_ror:8 row_mask:0xf bank_mask:0xf
    s_nop 0
    v_add_f32_dpp v202, v202, v202 row_ror:4 row_mask:0xf bank_mask:0xf
    v_add_f32_dpp v203, v203, v203 row_ror:4 row_mask:0xf bank_mask:0xf
    ds_write_b64 v65, v[202:203]
    s_cmp_lg_u32 s60, 0
    s_waitcnt lgkmcnt(0)
    s_barrier
    s_cbranch_scc1 L_P0L
    s_mov_b64 exec, 0xff
    ds_read_b128 v[0:3], v66 offset:0
    ds_read_b128 v[8:11], v66 offset:128
    ds_read_b128 v[16:19], v66 offset:256
    ds_read_b128 v[24:27], v66 offset:384
    s_waitcnt lgkmcnt(2)
    v_pk_add_f32 v[0:1], v[0:1], v[8:9]
    v_pk_add_f32 v[2:3], v[2:3], v[10:11]
    s_waitcnt lgkmcnt(0)
    v_pk_add_f32 v[16:17], v[16:17], v[24:25]
    v_pk_add_f32 v[18:19], v[18:19], v[26:27]
    v_pk_add_f32 v[0:1], v[0:1], v[16:17]
    v_pk_add_f32 v[2:3], v[2:3], v[18:19]
    v_cvt_pk_bf16_f32 v0, v0, v1
    v_cvt_pk_bf16_f32 v2, v2, v3
    v_and_b32 v1, 0xffff0000, v0
    v_lshlrev_b32 v0, 16, v0
    v_and_b32 v3, 0xffff0000, v2
    v_lshlrev_b32 v2, 16, v2
    v_pk_add_f32 v[0:1], v[0:1], s[66:67]
    v_pk_add_f32 v[2:3], v[2:3], s[66:67]
    v_cvt_pk_bf16_f32 v72, v0, v1
    v_cvt_pk_bf16_f32 v73, v2, v3
    buffer_store_dwordx4 v[72:75], v67, s[32:35], s65 offen sc1
    s_mov_b64 exec, -1
    s_nop 0
L_P0L:
    s_waitcnt vmcnt(9)
    v_dot2_f32_bf16 v104, s41, v4, 0
    buffer_load_dwordx4 v[84:87], v255, s[4:7], s77 offen offset:2048
    v_dot2_f32_bf16 v120, v4, v4, 0
    s_waitcnt vmcnt(9)
    v_dot2_f32_bf16 v105, s41, v12, 0
    v_dot2_f32_bf16 v121, v12, v12, 0
    v_dot2c_f32_bf16 v104, s41, v5
    v_dot2c_f32_bf16 v120, v5, v5
    v_dot2c_f32_bf16 v105, s41, v13
    v_dot2c_f32_bf16 v121, v13, v13
    v_dot2c_f32_bf16 v104, s41, v6
    v_dot2c_f32_bf16 v120, v6, v6
    v_dot2c_f32_bf16 v105, s41, v14
    v_dot2c_f32_bf16 v121, v14, v14
    v_dot2c_f32_bf16 v104, s41, v7
    buffer_load_dwordx4 v[92:95], v255, s[4:7], s77 offen offset:3072
    v_dot2c_f32_bf16 v120, v7, v7
    v_dot2c_f32_bf16 v105, s41, v15
    v_dot2c_f32_bf16 v121, v15, v15
    s_waitcnt vmcnt(9)
    v_dot2_f32_bf16 v106, s41, v20, 0
    v_dot2_f32_bf16 v122, v20, v20, 0
    s_waitcnt vmcnt(8)
    v_dot2_f32_bf16 v107, s41, v28, 0
    v_dot2_f32_bf16 v123, v28, v28, 0
    v_dot2c_f32_bf16 v106, s41, v21
    v_dot2c_f32_bf16 v122, v21, v21
    v_dot2c_f32_bf16 v107, s41, v29
    v_dot2c_f32_bf16 v123, v29, v29
    v_dot2c_f32_bf16 v106, s41, v22
    s_add_u32 m0, s52, 73728
    s_nop 0
    buffer_load_dwordx4 v246, s[8:11], s51 offen offset:0 lds
    v_dot2c_f32_bf16 v122, v22, v22
    v_dot2c_f32_bf16 v107, s41, v30
    v_dot2c_f32_bf16 v123, v30, v30
    v_dot2c_f32_bf16 v106, s41, v23
    v_dot2c_f32_bf16 v122, v23, v23
    v_dot2c_f32_bf16 v107, s41, v31
    v_dot2c_f32_bf16 v123, v31, v31
    v_lshlrev_b32 v0, 16, v4
    v_and_b32 v1, 0xffff0000, v4
    v_lshlrev_b32 v2, 16, v5
    v_and_b32 v3, 0xffff0000, v5
    v_lshlrev_b32 v4, 16, v6
    buffer_load_dwordx4 v246, s[8:11], s51 offen offset:1024 lds
    v_and_b32 v5, 0xffff0000, v6
    v_lshlrev_b32 v6, 16, v7
    v_and_b32 v7, 0xffff0000, v7
    v_lshlrev_b32 v8, 16, v12
    v_and_b32 v9, 0xffff0000, v12
    v_lshlrev_b32 v10, 16, v13
    v_and_b32 v11, 0xffff0000, v13
    v_lshlrev_b32 v12, 16, v14
    v_and_b32 v13, 0xffff0000, v14
    v_lshlrev_b32 v14, 16, v15
    v_and_b32 v15, 0xffff0000, v15
    s_waitcnt vmcnt(9)
    v_dot2_f32_bf16 v108, s41, v36, 0
    buffer_load_dwordx4 v246, s[8:11], s51 offen offset:2048 lds
    s_add_u32 s51, s51, 98304
    v_dot2_f32_bf16 v124, v36, v36, 0
    s_waitcnt vmcnt(9)
    v_dot2_f32_bf16 v109, s41, v44, 0
    v_dot2_f32_bf16 v125, v44, v44, 0
    v_dot2c_f32_bf16 v108, s41, v37
    v_dot2c_f32_bf16 v124, v37, v37
    v_dot2c_f32_bf16 v109, s41, v45
    v_dot2c_f32_bf16 v125, v45, v45
    v_dot2c_f32_bf16 v108, s41, v38
    v_dot2c_f32_bf16 v124, v38, v38
    v_dot2c_f32_bf16 v109, s41, v46
    v_dot2c_f32_bf16 v125, v46, v46
    v_dot2c_f32_bf16 v108, s41, v39
    s_add_u32 m0, s52, 86016
    s_nop 0
    buffer_load_dwordx4 v246, s[8:11], s51 offen offset:0 lds
    v_dot2c_f32_bf16 v124, v39, v39
    v_dot2c_f32_bf16 v109, s41, v47
    v_dot2c_f32_bf16 v125, v47, v47
    v_lshlrev_b32 v16, 16, v20
    v_and_b32 v17, 0xffff0000, v20
    v_lshlrev_b32 v18, 16, v21
    v_and_b32 v19, 0xffff0000, v21
    v_lshlrev_b32 v20, 16, v22
    v_and_b32 v21, 0xffff0000, v22
    v_lshlrev_b32 v22, 16, v23
    v_and_b32 v23, 0xffff0000, v23
    v_lshlrev_b32 v24, 16, v28
    buffer_load_dwordx4 v246, s[8:11], s51 offen offset:1024 lds
    v_and_b32 v25, 0xffff0000, v28
    v_lshlrev_b32 v26, 16, v29
    v_and_b32 v27, 0xffff0000, v29
    v_lshlrev_b32 v28, 16, v30
    v_and_b32 v29, 0xffff0000, v30
    v_lshlrev_b32 v30, 16, v31
    v_and_b32 v31, 0xffff0000, v31
    s_waitcnt vmcnt(10)
    v_dot2_f32_bf16 v110, s41, v52, 0
    v_dot2_f32_bf16 v126, v52, v52, 0
    s_waitcnt vmcnt(9)
    v_dot2_f32_bf16 v111, s41, v60, 0
    v_dot2_f32_bf16 v127, v60, v60, 0
    v_dot2c_f32_bf16 v110, s41, v53
    buffer_load_dwordx4 v246, s[8:11], s51 offen offset:2048 lds
    s_add_u32 s51, s51, 98304
    v_dot2c_f32_bf16 v126, v53, v53
    v_dot2c_f32_bf16 v111, s41, v61
    v_dot2c_f32_bf16 v127, v61, v61
    v_dot2c_f32_bf16 v110, s41, v54
    v_dot2c_f32_bf16 v126, v54, v54
    v_dot2c_f32_bf16 v111, s41, v62
    v_dot2c_f32_bf16 v127, v62, v62
    v_dot2c_f32_bf16 v110, s41, v55
    v_dot2c_f32_bf16 v126, v55, v55
    v_dot2c_f32_bf16 v111, s41, v63
    v_dot2c_f32_bf16 v127, v63, v63
    s_waitcnt vmcnt(6)
    s_nop 0
    s_branch L_J
L_END:
    s_endpgm
.section .rodata,"a"
.p2align 6
.amdhsa_kernel adaLN_cond__sliding_local_dilated__dense_activation_relu__prompt_kernel
  .amdhsa_next_free_vgpr 512
  .amdhsa_next_free_sgpr 102
  .amdhsa_accum_offset 256
  .amdhsa_group_segment_fixed_size 0
  .amdhsa_kernarg_size 88
  .amdhsa_user_sgpr_count 2
  .amdhsa_user_sgpr_kernarg_segment_ptr 1
  .amdhsa_system_sgpr_workgroup_id_x 1
.end_amdhsa_kernel
```
